```python
import torch

def _softmax(x, axis=-1):
    return torch.softmax(x, dim=axis)
def _gelu(x):
    return torch.nn.functional.gelu(x, approximate="tanh")
def _silu(x):
    return torch.nn.functional.silu(x)
def _sigmoid(x):
    return torch.sigmoid(x)
def _layernorm(x, axis=-1, eps=1e-5):
    m = x.mean(dim=axis, keepdim=True)
    v = x.var(dim=axis, keepdim=True, unbiased=False)
    return (x - m) / torch.sqrt(v + eps)
def _scatter_add(tgt, idx, src, axis=0):
    return tgt.clone().index_add_(axis, idx, src)
def _segment_sum(src, seg, n):
    out = torch.zeros((n,) + src.shape[1:], dtype=src.dtype)
    return out.index_add_(0, seg, src)
def _pad(x, pw):
    flat = tuple(v for pair in reversed(pw) for v in pair)
    return torch.nn.functional.pad(x, flat)

kernel_name = 'concat_heads__gqa_block_cached__mha_block_cached__near_ridge'

def setup_inputs():

    _w = (lambda a: (lambda t: t.to(torch.bfloat16) if t.is_floating_point() else t)(torch.as_tensor(a)))
    def _A_setup():
        B, Sq, D = 8, 64, 448
        Hq, Hkv, Sk, Dh = 16, 8, 512, 256
        assert Hq % Hkv == 0, (Hq, Hkv)
        return {
            "x": _w((lambda *s: torch.randn(*s, dtype=torch.bfloat16) * 0.8)(B, Sq, D)),
            "k_cache": _w((lambda *s: torch.randn(*s, dtype=torch.bfloat16) * 0.8)(B, Hkv, Sk, Dh)),
            "v_cache": _w((lambda *s: torch.randn(*s, dtype=torch.bfloat16) * 0.05)(B, Hkv, Sk, Dh)),
            "wq": _w((lambda *s: torch.randn(*s, dtype=torch.bfloat16) * 0.8)(D, Hq * Dh) * (D ** -0.5)),
            "wo": _w((lambda *s: torch.randn(*s, dtype=torch.bfloat16) * 0.05)(Hq * Dh, D) * ((Hq * Dh) ** -0.5)),
        }
    _A_in = _A_setup()

    def _B_setup():
        B, Sq, D = 8, 64, 448
        H, Sk, Dh = 16, 512, 256
        return {
            "x": _w((lambda *s: torch.randn(*s, dtype=torch.bfloat16) * 0.8)(B, Sq, D)),
            "k_cache": _w((lambda *s: torch.randn(*s, dtype=torch.bfloat16) * 0.8)(B, H, Sk, Dh)),
            "v_cache": _w((lambda *s: torch.randn(*s, dtype=torch.bfloat16) * 0.05)(B, H, Sk, Dh)),
            "wq": _w((lambda *s: torch.randn(*s, dtype=torch.bfloat16) * 0.8)(D, H * Dh) * (D ** -0.5)),
            "wo": _w((lambda *s: torch.randn(*s, dtype=torch.bfloat16) * 0.05)(H * Dh, D) * ((H * Dh) ** -0.5)),
        }
    _B_in = _B_setup()

    return {
        "A_x": _A_in["x"],
        "A_k_cache": _A_in["k_cache"],
        "A_v_cache": _A_in["v_cache"],
        "A_wq": _A_in["wq"],
        "A_wo": _A_in["wo"],
        "B_x": _B_in["x"],
        "B_k_cache": _B_in["k_cache"],
        "B_v_cache": _B_in["v_cache"],
        "B_wq": _B_in["wq"],
        "B_wo": _B_in["wo"],
    }

def reference(A_x, A_k_cache, A_v_cache, A_wq, A_wo, B_x, B_k_cache, B_v_cache, B_wq, B_wo):
    def _A_ref(x, k_cache, v_cache, wq, wo):
        B, Sq, D = x.shape
        Hq, Dh = 16, 256
        Hkv = k_cache.shape[1]
        rep = Hq // Hkv
        q = (lambda x, *d: x.permute(*d))((x @ wq).reshape(B, Sq, Hq, Dh), 0, 2, 1, 3)
        k = (lambda x, n, axis: torch.repeat_interleave(x, n, dim=axis))(k_cache, rep, axis=1)
        v = (lambda x, n, axis: torch.repeat_interleave(x, n, dim=axis))(v_cache, rep, axis=1)
        scores = torch.einsum("bhqd,bhkd->bhqk", q, k) * (Dh ** -0.5)
        p = _softmax(scores, axis=-1)
        o = torch.einsum("bhqk,bhkd->bhqd", p, v)
        return (lambda x, *d: x.permute(*d))(o, 0, 2, 1, 3).reshape(B, Sq, Hq * Dh) @ wo

    def _B_ref(x, k_cache, v_cache, wq, wo):
        B, Sq, D = x.shape
        H, Dh = 16, 256
        q = (lambda x, *d: x.permute(*d))((x @ wq).reshape(B, Sq, H, Dh), 0, 2, 1, 3)
        scores = torch.einsum("bhqd,bhkd->bhqk", q, k_cache) * (Dh ** -0.5)
        p = _softmax(scores, axis=-1)
        o = torch.einsum("bhqk,bhkd->bhqd", p, v_cache)
        return (lambda x, *d: x.permute(*d))(o, 0, 2, 1, 3).reshape(B, Sq, H * Dh) @ wo

    a = _A_ref(A_x, A_k_cache, A_v_cache, A_wq, A_wo)
    b = _B_ref(B_x, B_k_cache, B_v_cache, B_wq, B_wo)
    return torch.concatenate([a, b], axis=-1)
```

```asm
; @launch grid=(256,1,1) block=(256,1,1) lds=163840
.amdgcn_target "amdgcn-amd-amdhsa--gfx950"
.text
.globl concat_heads__gqa_block_cached__mha_block_cached__near_ridge_kernel
.p2align 8
.type concat_heads__gqa_block_cached__mha_block_cached__near_ridge_kernel,@function
concat_heads__gqa_block_cached__mha_block_cached__near_ridge_kernel:
    s_cmp_ge_u32 s2, 256
    s_cbranch_scc1 L_main_end
    s_load_dwordx16 s[36:51], s[0:1], 0
    s_load_dwordx4 s[52:55], s[0:1], 64
    s_load_dwordx4 s[92:95], s[0:1], 80
    s_load_dwordx2 s[56:57], s[0:1], 96
    v_lshrrev_b32 v40, 6, v0
    v_and_b32 v0, 63, v0
    v_readfirstlane_b32 s58, v40
    s_and_b32 s3, s2, 7
    s_lshr_b32 s59, s2, 7
    s_bfe_u32 s60, s2, 0x30004
    s_bfe_u32 s69, s2, 0x10003
    s_mul_i32 s63, s58, 3584
    v_lshl_add_u32 v41, v0, 4, s63
    s_mul_i32 s64, s60, 57344
    s_mul_i32 s65, s58, 3712
    s_lshl1_add_u32 s61, s3, s69
    s_lshl_b32 s63, s61, 9
    s_getpc_b64 s[4:5]
L_pc_base:
    s_lshr_b32 s6, s2, 3
    s_lshl2_add_u32 s6, s6, s58
    s_mul_i32 s6, s6, 2
    v_add_u32 v42, s6, v0
    v_lshlrev_b32 v42, 7, v42
    v_min_u32 v42, L_main_end-L_pc_base, v42
    v_mov_b32 v43, s5
    v_add_co_u32 v42, vcc, s4, v42
    s_nop 1
    v_addc_co_u32 v43, vcc, 0, v43, vcc
    s_mov_b64 exec, 3
    global_load_dword v36, v[42:43], off
    s_mov_b64 exec, -1
    s_waitcnt lgkmcnt(0)
    s_cmp_eq_u32 s59, 0
    s_cselect_b32 s8, s36, s46
    s_cselect_b32 s9, s37, s47
    s_add_u32 s8, s8, s64
    s_addc_u32 s9, s9, 0
    s_mov_b32 s10, 57344
    s_mov_b32 s11, 0x00020000
    s_mov_b32 exec_hi, 0x00ffffff
    s_add_u32 m0, s65, 131072
    s_mov_b32 s66, 0
    buffer_load_dwordx4 v41, s[8:11], s66 offen offset:0  lds
    s_add_u32 m0, s65, 131104
    s_nop 0
    buffer_load_dwordx4 v41, s[8:11], s66 offen offset:896  lds
    s_add_u32 m0, s65, 131136
    s_nop 0
    buffer_load_dwordx4 v41, s[8:11], s66 offen offset:1792  lds
    s_add_u32 m0, s65, 131168
    s_nop 0
    buffer_load_dwordx4 v41, s[8:11], s66 offen offset:2688  lds
    s_add_u32 m0, s65, 147456
    s_mov_b32 s66, 14336
    buffer_load_dwordx4 v41, s[8:11], s66 offen offset:0  lds
    s_add_u32 m0, s65, 147488
    s_nop 0
    buffer_load_dwordx4 v41, s[8:11], s66 offen offset:896  lds
    s_add_u32 m0, s65, 147520
    s_nop 0
    buffer_load_dwordx4 v41, s[8:11], s66 offen offset:1792  lds
    s_add_u32 m0, s65, 147552
    s_nop 0
    buffer_load_dwordx4 v41, s[8:11], s66 offen offset:2688  lds
    s_add_u32 m0, s65, 32768
    s_mov_b32 s66, 28672
    buffer_load_dwordx4 v41, s[8:11], s66 offen offset:0  lds
    s_add_u32 m0, s65, 32800
    s_nop 0
    buffer_load_dwordx4 v41, s[8:11], s66 offen offset:896  lds
    s_add_u32 m0, s65, 32832
    s_nop 0
    buffer_load_dwordx4 v41, s[8:11], s66 offen offset:1792  lds
    s_mov_b32 exec_hi, -1
    s_cmp_eq_u32 s59, 0
    s_cselect_b32 s20, s42, s52
    s_cselect_b32 s21, s43, s53
    s_add_u32 s20, s20, s63
    s_addc_u32 s21, s21, 0
    s_mov_b32 s22, 0
    s_mov_b32 s23, 0x00020000
    s_sub_u32 s22, 3670016, s63
    s_lshl_b32 s67, s58, 12
    s_lshl_b32 s68, s58, 10
    s_lshr_b32 s62, s60, 2
    s_mul_i32 s74, s62, 1835008
    s_sub_u32 s75, 1835008, s74
    s_add_u32 s6, s60, 0
    s_and_b32 s6, s6, 3
    s_lshl_b32 s80, s6, 7
    s_mul_i32 s84, s6, 57344
    v_lshrrev_b32 v42, 3, v0
    v_and_b32 v43, 7, v0
    v_and_b32 v44, 2, v42
    s_and_b32 s6, s58, 1
    s_lshl_b32 s6, s6, 2
    v_xor_b32 v44, v44, v43
    v_xor_b32 v44, s6, v44
    s_lshl_b32 s6, s58, 16
    v_lshl_add_u32 v45, v42, 13, s6
    v_lshl_add_u32 v1, v44, 4, v45
    s_lshl4_add_u32 s6, s60, s61
    s_lshl3_add_u32 s5, s60, s3
    s_cmp_eq_u32 s59, 0
    s_cselect_b32 s6, s5, s6
    s_lshl_b32 s88, s6, 18
    s_cmp_eq_u32 s59, 0
    s_cselect_b32 s12, s38, s48
    s_cselect_b32 s13, s39, s49
    s_add_u32 s12, s12, s88
    s_addc_u32 s13, s13, 0
    s_mov_b32 s14, 262144
    s_mov_b32 s15, 0x00020000
    v_and_b32 v45, 1, v42
    v_lshrrev_b32 v46, 1, v42
    v_lshl_add_u32 v45, v46, 3, v45
    s_lshl_b32 s6, s58, 14
    v_lshl_add_u32 v45, v45, 9, s6
    v_and_b32 v44, 6, v42
    v_xor_b32 v44, v44, v43
    v_lshl_add_u32 v4, v44, 4, v45
    v_xor_b32 v46, v46, v43
    v_lshl_add_u32 v2, v46, 4, v45
    v_xor_b32 v3, 64, v2
    v_lshrrev_b32 v51, 4, v0
    v_and_b32 v57, 15, v0
    v_mul_u32_u24 v57, 928, v57
    v_lshl_add_u32 v57, v51, 4, v57
    s_mul_i32 s6, s62, 448
    v_add_u32 v110, s6, v57
    s_sub_u32 s6, 448, s6
    v_add_u32 v111, s6, v57
    v_add_u32 v108, 131072, v110
    v_add_u32 v109, 131072, v111
    v_bfe_u32 v53, v0, 2, 2
    v_bfe_u32 v54, v0, 3, 2
    v_xor_b32 v54, s58, v54
    v_and_b32 v55, 3, v0
    v_lshl_add_u32 v54, v54, 2, v55
    v_lshl_add_u32 v56, v51, 3, v53
    v_lshl_add_u32 v56, v56, 4, v54
    v_lshlrev_b32 v56, 3, v56
    v_add_u32 v12, 0x10000, v56
    s_mov_b32 exec_hi, 0x00ffffff
    s_add_u32 m0, s65, 32864
    s_nop 0
    buffer_load_dwordx4 v41, s[8:11], s66 offen offset:2688  lds
    s_add_u32 m0, s65, 49152
    s_mov_b32 s66, 43008
    buffer_load_dwordx4 v41, s[8:11], s66 offen offset:0  lds
    s_add_u32 m0, s65, 49184
    s_nop 0
    buffer_load_dwordx4 v41, s[8:11], s66 offen offset:896  lds
    s_add_u32 m0, s65, 49216
    s_nop 0
    buffer_load_dwordx4 v41, s[8:11], s66 offen offset:1792  lds
    s_add_u32 m0, s65, 49248
    s_nop 0
    buffer_load_dwordx4 v41, s[8:11], s66 offen offset:2688  lds
    s_mov_b32 exec_hi, -1
    s_add_u32 m0, s68, 65536
    s_add_u32 s66, s74, s80
    buffer_load_dwordx4 v1, s[20:23], s66 offen  lds
    s_add_u32 m0, s68, 69632
    s_add_u32 s66, s66, 0x40000
    buffer_load_dwordx4 v1, s[20:23], s66 offen  lds
    s_add_u32 m0, s68, 73728
    s_add_u32 s66, s66, 0x40000
    buffer_load_dwordx4 v1, s[20:23], s66 offen  lds
    s_add_u32 m0, s68, 77824
    s_add_u32 s66, s66, 0x40000
    buffer_load_dwordx4 v1, s[20:23], s66 offen  lds
    s_add_u32 m0, s68, 81920
    s_add_u32 s66, s66, 0x40000
    buffer_load_dwordx4 v1, s[20:23], s66 offen  lds
    s_add_u32 m0, s68, 86016
    s_add_u32 s66, s66, 0x40000
    buffer_load_dwordx4 v1, s[20:23], s66 offen  lds
    s_add_u32 m0, s68, 90112
    s_add_u32 s66, s66, 0x40000
    buffer_load_dwordx4 v1, s[20:23], s66 offen  lds
    s_add_u32 m0, s68, 98304
    s_add_u32 s66, s75, s80
    buffer_load_dwordx4 v1, s[20:23], s66 offen  lds
    s_add_u32 m0, s68, 102400
    s_add_u32 s66, s66, 0x40000
    buffer_load_dwordx4 v1, s[20:23], s66 offen  lds
    s_add_u32 m0, s68, 106496
    s_add_u32 s66, s66, 0x40000
    buffer_load_dwordx4 v1, s[20:23], s66 offen  lds
    s_add_u32 m0, s68, 110592
    s_add_u32 s66, s66, 0x40000
    buffer_load_dwordx4 v1, s[20:23], s66 offen  lds
    s_add_u32 m0, s68, 114688
    s_add_u32 s66, s66, 0x40000
    buffer_load_dwordx4 v1, s[20:23], s66 offen  lds
    s_add_u32 m0, s68, 118784
    s_add_u32 s66, s66, 0x40000
    buffer_load_dwordx4 v1, s[20:23], s66 offen  lds
    s_add_u32 m0, s68, 122880
    s_add_u32 s66, s66, 0x40000
    buffer_load_dwordx4 v1, s[20:23], s66 offen  lds
    s_waitcnt vmcnt(14) lgkmcnt(0)
    s_barrier
    ds_read_b128 a[0:3], v108 offset:0
    ds_read_b128 a[4:7], v108 offset:16384
    ds_read_b128 a[8:11], v110 offset:32768
    ds_read_b128 a[12:15], v110 offset:49152
    ds_read_b128 a[16:19], v108 offset:64
    ds_read_b128 a[20:23], v108 offset:16448
    ds_read_b128 a[24:27], v110 offset:32832
    ds_read_b128 a[28:31], v110 offset:49216
    ds_read_b128 a[32:35], v108 offset:128
    ds_read_b128 a[36:39], v108 offset:16512
    ds_read_b128 a[40:43], v110 offset:32896
    ds_read_b128 a[44:47], v110 offset:49280
    ds_read_b128 a[48:51], v108 offset:192
    ds_read_b128 a[52:55], v108 offset:16576
    ds_read_b128 a[56:59], v110 offset:32960
    ds_read_b128 a[60:63], v110 offset:49344
    ds_read_b128 a[64:67], v108 offset:256
    ds_read_b128 a[68:71], v108 offset:16640
    ds_read_b128 a[72:75], v110 offset:33024
    ds_read_b128 a[76:79], v110 offset:49408
    ds_read_b128 a[80:83], v108 offset:320
    ds_read_b128 a[84:87], v108 offset:16704
    ds_read_b128 a[88:91], v110 offset:33088
    ds_read_b128 a[92:95], v110 offset:49472
    ds_read_b128 a[96:99], v108 offset:384
    ds_read_b128 a[100:103], v108 offset:16768
    ds_read_b128 a[104:107], v110 offset:33152
    ds_read_b128 a[108:111], v110 offset:49536
    s_add_u32 m0, s67, 0
    s_add_u32 s66, s80, 0
    buffer_load_dwordx4 v2, s[12:15], s66 offen offset:0 nt lds
    buffer_load_dwordx4 v3, s[12:15], s66 offen offset:1024 nt lds
    buffer_load_dwordx4 v2, s[12:15], s66 offen offset:2048 nt lds
    buffer_load_dwordx4 v3, s[12:15], s66 offen offset:3072 nt lds
    ds_read_b128 a[112:115], v109 offset:0
    ds_read_b128 a[116:119], v109 offset:16384
    ds_read_b128 a[120:123], v111 offset:32768
    ds_read_b128 a[124:127], v111 offset:49152
    ds_read_b128 a[128:131], v109 offset:64
    ds_read_b128 a[132:135], v109 offset:16448
    ds_read_b128 a[136:139], v111 offset:32832
    ds_read_b128 a[140:143], v111 offset:49216
    ds_read_b128 a[144:147], v109 offset:128
    ds_read_b128 a[148:151], v109 offset:16512
    ds_read_b128 a[152:155], v111 offset:32896
    ds_read_b128 a[156:159], v111 offset:49280
    ds_read_b128 a[160:163], v109 offset:192
    ds_read_b128 a[164:167], v109 offset:16576
    ds_read_b128 a[168:171], v111 offset:32960
    ds_read_b128 a[172:175], v111 offset:49344
    ds_read_b128 a[176:179], v109 offset:256
    ds_read_b128 a[180:183], v109 offset:16640
    ds_read_b128 a[184:187], v111 offset:33024
    ds_read_b128 a[188:191], v111 offset:49408
    ds_read_b128 a[192:195], v109 offset:320
    ds_read_b128 a[196:199], v109 offset:16704
    ds_read_b128 a[200:203], v111 offset:33088
    ds_read_b128 a[204:207], v111 offset:49472
    ds_read_b128 a[208:211], v109 offset:384
    ds_read_b128 a[212:215], v109 offset:16768
    ds_read_b128 a[216:219], v111 offset:33152
    ds_read_b128 a[220:223], v111 offset:49536
    s_add_u32 m0, s67, 16384
    s_add_u32 s66, s80, 65536
    buffer_load_dwordx4 v2, s[12:15], s66 offen offset:0 nt lds
    buffer_load_dwordx4 v3, s[12:15], s66 offen offset:1024 nt lds
    buffer_load_dwordx4 v2, s[12:15], s66 offen offset:2048 nt lds
    buffer_load_dwordx4 v3, s[12:15], s66 offen offset:3072 nt lds
    s_waitcnt vmcnt(18) lgkmcnt(0)
    s_barrier
    ds_read_b64_tr_b16 a[224:225], v12 offset:0
    ds_read_b64_tr_b16 a[226:227], v12 offset:512
    ds_read_b64_tr_b16 a[228:229], v12 offset:4096
    ds_read_b64_tr_b16 a[230:231], v12 offset:4608
    ds_read_b64_tr_b16 a[232:233], v12 offset:8192
    ds_read_b64_tr_b16 a[234:235], v12 offset:8704
    ds_read_b64_tr_b16 a[236:237], v12 offset:12288
    ds_read_b64_tr_b16 a[238:239], v12 offset:12800
    v_and_b32 v100, 15, v0
    v_lshrrev_b32 v101, 4, v0
    v_lshl_add_u32 v102, v100, 7, s67
    v_bfe_u32 v103, v0, 1, 3
    v_xor_b32 v103, v103, v101
    v_lshl_add_u32 v13, v103, 4, v102
    v_xor_b32 v14, 64, v13
    s_mov_b32 s6, 131072
    v_lshl_add_u32 v29, v0, 4, s6
    s_lshr_b32 s5, s58, 1
    s_lshl_b32 s5, s5, 12
    s_add_u32 s6, s6, s5
    s_and_b32 s5, s58, 1
    s_lshl3_add_u32 s7, s5, s6
    v_lshl_add_u32 v28, v0, 4, s7
    s_lshl_b32 s5, s5, 9
    s_add_u32 s6, s6, s5
    v_lshrrev_b32 v102, 5, v0
    v_lshl_add_u32 v102, v102, 4, v100
    v_and_b32 v103, 1, v101
    v_lshl_add_u32 v102, v102, 1, v103
    v_lshl_add_u32 v27, v102, 3, s6
    s_add_u32 s6, s60, 1
    s_and_b32 s6, s6, 3
    s_lshl_b32 s81, s6, 7
    s_mul_i32 s85, s6, 57344
    s_add_u32 m0, s67, 32768
    s_add_u32 s66, s80, 131072
    buffer_load_dwordx4 v2, s[12:15], s66 offen offset:0 nt lds
    buffer_load_dwordx4 v3, s[12:15], s66 offen offset:1024 nt lds
    buffer_load_dwordx4 v2, s[12:15], s66 offen offset:2048 nt lds
    buffer_load_dwordx4 v3, s[12:15], s66 offen offset:3072 nt lds
    s_waitcnt vmcnt(19) lgkmcnt(0)
    s_barrier
    v_mfma_f32_16x16x32_bf16 v[48:51], a[224:227], a[0:3], 0
    ds_read_b64_tr_b16 a[240:241], v12 offset:16384
    ds_read_b64_tr_b16 a[242:243], v12 offset:16896
    v_mfma_f32_16x16x32_bf16 v[48:51], a[228:231], a[16:19], v[48:51]
    ds_read_b64_tr_b16 a[244:245], v12 offset:20480
    ds_read_b64_tr_b16 a[246:247], v12 offset:20992
    v_mfma_f32_16x16x32_bf16 v[48:51], a[232:235], a[32:35], v[48:51]
    ds_read_b64_tr_b16 a[248:249], v12 offset:24576
    ds_read_b64_tr_b16 a[250:251], v12 offset:25088
    v_mfma_f32_16x16x32_bf16 v[48:51], a[236:239], a[48:51], v[48:51]
    v_mfma_f32_16x16x32_bf16 v[52:55], a[236:239], a[52:55], 0
    v_mfma_f32_16x16x32_bf16 v[52:55], a[232:235], a[36:39], v[52:55]
    v_mfma_f32_16x16x32_bf16 v[52:55], a[228:231], a[20:23], v[52:55]
    v_mfma_f32_16x16x32_bf16 v[52:55], a[224:227], a[4:7], v[52:55]
    v_mfma_f32_16x16x32_bf16 v[56:59], a[224:227], a[8:11], 0
    v_mfma_f32_16x16x32_bf16 v[56:59], a[228:231], a[24:27], v[56:59]
    v_mfma_f32_16x16x32_bf16 v[56:59], a[232:235], a[40:43], v[56:59]
    v_mfma_f32_16x16x32_bf16 v[56:59], a[236:239], a[56:59], v[56:59]
    v_mfma_f32_16x16x32_bf16 v[60:63], a[236:239], a[60:63], 0
    v_mfma_f32_16x16x32_bf16 v[60:63], a[232:235], a[44:47], v[60:63]
    v_mfma_f32_16x16x32_bf16 v[60:63], a[228:231], a[28:31], v[60:63]
    v_mfma_f32_16x16x32_bf16 v[60:63], a[224:227], a[12:15], v[60:63]
    s_add_u32 m0, s67, 49152
    s_add_u32 s66, s80, 196608
    buffer_load_dwordx4 v2, s[12:15], s66 offen offset:0 nt lds
    buffer_load_dwordx4 v3, s[12:15], s66 offen offset:1024 nt lds
    buffer_load_dwordx4 v2, s[12:15], s66 offen offset:2048 nt lds
    buffer_load_dwordx4 v3, s[12:15], s66 offen offset:3072 nt lds
    s_waitcnt vmcnt(19) lgkmcnt(0)
    s_barrier
    v_mfma_f32_16x16x32_bf16 v[48:51], a[240:243], a[64:67], v[48:51]
    ds_read_b64_tr_b16 a[224:225], v12 offset:32768
    ds_read_b64_tr_b16 a[226:227], v12 offset:33280
    v_mfma_f32_16x16x32_bf16 v[48:51], a[244:247], a[80:83], v[48:51]
    ds_read_b64_tr_b16 a[228:229], v12 offset:36864
    ds_read_b64_tr_b16 a[230:231], v12 offset:37376
    v_mfma_f32_16x16x32_bf16 v[48:51], a[248:251], a[96:99], v[48:51]
    ds_read_b64_tr_b16 a[232:233], v12 offset:40960
    ds_read_b64_tr_b16 a[234:235], v12 offset:41472
    v_mfma_f32_16x16x32_bf16 v[52:55], a[248:251], a[100:103], v[52:55]
    ds_read_b64_tr_b16 a[236:237], v12 offset:45056
    ds_read_b64_tr_b16 a[238:239], v12 offset:45568
    v_mfma_f32_16x16x32_bf16 v[52:55], a[244:247], a[84:87], v[52:55]
    v_mfma_f32_16x16x32_bf16 v[52:55], a[240:243], a[68:71], v[52:55]
    v_mfma_f32_16x16x32_bf16 v[56:59], a[240:243], a[72:75], v[56:59]
    v_mfma_f32_16x16x32_bf16 v[56:59], a[244:247], a[88:91], v[56:59]
    v_mfma_f32_16x16x32_bf16 v[56:59], a[248:251], a[104:107], v[56:59]
    v_mfma_f32_16x16x32_bf16 v[60:63], a[248:251], a[108:111], v[60:63]
    v_mfma_f32_16x16x32_bf16 v[60:63], a[244:247], a[92:95], v[60:63]
    v_mfma_f32_16x16x32_bf16 v[60:63], a[240:243], a[76:79], v[60:63]
    s_waitcnt vmcnt(16) lgkmcnt(0)
    s_barrier
    v_mfma_f32_16x16x32_bf16 v[48:51], a[224:227], a[112:115], v[48:51]
    ds_read_b64_tr_b16 a[240:241], v12 offset:49152
    ds_read_b64_tr_b16 a[242:243], v12 offset:49664
    v_mfma_f32_16x16x32_bf16 v[48:51], a[228:231], a[128:131], v[48:51]
    ds_read_b64_tr_b16 a[244:245], v12 offset:53248
    ds_read_b64_tr_b16 a[246:247], v12 offset:53760
    v_mfma_f32_16x16x32_bf16 v[48:51], a[232:235], a[144:147], v[48:51]
    ds_read_b64_tr_b16 a[248:249], v12 offset:57344
    ds_read_b64_tr_b16 a[250:251], v12 offset:57856
    v_mfma_f32_16x16x32_bf16 v[48:51], a[236:239], a[160:163], v[48:51]
    v_mfma_f32_16x16x32_bf16 v[52:55], a[236:239], a[164:167], v[52:55]
    v_mfma_f32_16x16x32_bf16 v[52:55], a[232:235], a[148:151], v[52:55]
    v_mfma_f32_16x16x32_bf16 v[52:55], a[228:231], a[132:135], v[52:55]
    v_mfma_f32_16x16x32_bf16 v[52:55], a[224:227], a[116:119], v[52:55]
    v_mfma_f32_16x16x32_bf16 v[56:59], a[224:227], a[120:123], v[56:59]
    v_mfma_f32_16x16x32_bf16 v[56:59], a[228:231], a[136:139], v[56:59]
    v_mfma_f32_16x16x32_bf16 v[56:59], a[232:235], a[152:155], v[56:59]
    v_mfma_f32_16x16x32_bf16 v[56:59], a[236:239], a[168:171], v[56:59]
    v_mfma_f32_16x16x32_bf16 v[60:63], a[236:239], a[172:175], v[60:63]
    v_mfma_f32_16x16x32_bf16 v[60:63], a[232:235], a[156:159], v[60:63]
    v_mfma_f32_16x16x32_bf16 v[60:63], a[228:231], a[140:143], v[60:63]
    v_mfma_f32_16x16x32_bf16 v[60:63], a[224:227], a[124:127], v[60:63]
    s_cmp_eq_u32 s59, 0
    s_cselect_b32 s16, s40, s50
    s_cselect_b32 s17, s41, s51
    s_add_u32 s16, s16, s88
    s_addc_u32 s17, s17, 0
    s_mov_b32 s18, 262144
    s_mov_b32 s19, 0x00020000
    s_mul_i32 s63, s61, 229376
    s_cmp_eq_u32 s59, 0
    s_cselect_b32 s24, s44, s54
    s_cselect_b32 s25, s45, s55
    s_add_u32 s24, s24, s63
    s_addc_u32 s25, s25, 0
    s_mov_b32 s26, 229376
    s_mov_b32 s27, 0x00020000
    s_lshl3_add_u32 s64, s59, s60
    s_lshl4_add_u32 s6, s64, s61
    s_mul_i32 s63, s6, 57344
    s_add_u32 s28, s56, s63
    s_addc_u32 s29, s57, 0
    s_mov_b32 s30, 57344
    s_mov_b32 s31, 0x00020000
    s_lshl_b32 s6, s64, 12
    s_add_u32 s6, s6, 0xe00000
    s_add_u32 s32, s56, s6
    s_addc_u32 s33, s57, 0
    s_mov_b32 s34, 64
    s_mov_b32 s35, 0x00020000
    s_lshl_b32 s6, s64, 2
    s_add_u32 s8, s94, s6
    s_addc_u32 s9, s95, 0
    s_mov_b32 s10, 4
    s_or_b32 s6, s61, s58
    s_cmp_eq_u32 s6, 0
    s_cselect_b32 s6, 0, 0x80000000
    v_lshl_add_u32 v37, v0, 2, s6
    s_waitcnt vmcnt(12) lgkmcnt(0)
    v_mfma_f32_16x16x32_bf16 v[48:51], a[240:243], a[176:179], v[48:51]
    ds_read_b128 a[224:227], v13 offset:0
    ds_read_b128 a[228:231], v13 offset:2048
    v_mfma_f32_16x16x32_bf16 v[48:51], a[244:247], a[192:195], v[48:51]
    ds_read_b128 a[232:235], v14 offset:0
    ds_read_b128 a[236:239], v14 offset:2048
    v_mfma_f32_16x16x32_bf16 v[48:51], a[248:251], a[208:211], v[48:51]
    v_mfma_f32_16x16x32_bf16 v[52:55], a[248:251], a[212:215], v[52:55]
    v_mfma_f32_16x16x32_bf16 v[52:55], a[244:247], a[196:199], v[52:55]
    v_mfma_f32_16x16x32_bf16 v[52:55], a[240:243], a[180:183], v[52:55]
    v_mfma_f32_16x16x32_bf16 v[56:59], a[240:243], a[184:187], v[56:59]
    v_mfma_f32_16x16x32_bf16 v[56:59], a[244:247], a[200:203], v[56:59]
    v_mfma_f32_16x16x32_bf16 v[56:59], a[248:251], a[216:219], v[56:59]
    v_mfma_f32_16x16x32_bf16 v[60:63], a[248:251], a[220:223], v[60:63]
    v_mfma_f32_16x16x32_bf16 v[60:63], a[244:247], a[204:207], v[60:63]
    v_mfma_f32_16x16x32_bf16 v[60:63], a[240:243], a[188:191], v[60:63]
    v_cvt_pk_bf16_f32 v40, v48, v49
    v_cvt_pk_bf16_f32 v41, v50, v51
    v_cvt_pk_bf16_f32 v42, v52, v53
    v_cvt_pk_bf16_f32 v43, v54, v55
    s_nop 0
    v_cvt_pk_bf16_f32 v44, v56, v57
    v_cvt_pk_bf16_f32 v45, v58, v59
    s_nop 0
    v_cvt_pk_bf16_f32 v46, v60, v61
    v_cvt_pk_bf16_f32 v47, v62, v63
    ds_write_b64 v27, v[40:41] offset:0
    ds_write_b64 v27, v[42:43] offset:1024
    ds_write_b64 v27, v[44:45] offset:2048
    ds_write_b64 v27, v[46:47] offset:3072
    s_waitcnt vmcnt(8) lgkmcnt(0)
    s_barrier
    ds_read_b128 v[64:67], v29 offset:0
    ds_read_b128 v[80:83], v29 offset:4096
    ds_read_b128 v[68:71], v29 offset:1024
    ds_read_b128 v[84:87], v29 offset:5120
    ds_read_b128 v[72:75], v29 offset:2048
    ds_read_b128 v[88:91], v29 offset:6144
    ds_read_b128 v[76:79], v29 offset:3072
    ds_read_b128 v[92:95], v29 offset:7168
    s_waitcnt lgkmcnt(7)
    v_mfma_f32_16x16x32_bf16 v[128:131], a[224:227], v[64:67], 0
    ds_read_b128 a[240:243], v13 offset:16384
    ds_read_b128 a[244:247], v13 offset:18432
    s_waitcnt lgkmcnt(8)
    v_mfma_f32_16x16x32_bf16 v[128:131], a[232:235], v[80:83], v[128:131]
    ds_read_b128 a[248:251], v14 offset:16384
    ds_read_b128 a[252:255], v14 offset:18432
    v_mfma_f32_16x16x32_bf16 v[132:135], a[236:239], v[80:83], 0
    v_mfma_f32_16x16x32_bf16 v[132:135], a[228:231], v[64:67], v[132:135]
    s_add_u32 m0, s68, 65536
    s_add_u32 s66, s74, s81
    buffer_load_dwordx4 v1, s[20:23], s66 offen  lds
    s_waitcnt lgkmcnt(9)
    v_mfma_f32_16x16x32_bf16 v[140:143], a[228:231], v[68:71], 0
    s_waitcnt lgkmcnt(8)
    v_mfma_f32_16x16x32_bf16 v[140:143], a[236:239], v[84:87], v[140:143]
    s_add_u32 m0, s68, 69632
    s_add_u32 s66, s66, 0x40000
    buffer_load_dwordx4 v1, s[20:23], s66 offen  lds
    v_mfma_f32_16x16x32_bf16 v[136:139], a[232:235], v[84:87], 0
    v_mfma_f32_16x16x32_bf16 v[136:139], a[224:227], v[68:71], v[136:139]
    s_add_u32 m0, s68, 73728
    s_add_u32 s66, s66, 0x40000
    buffer_load_dwordx4 v1, s[20:23], s66 offen  lds
    s_waitcnt lgkmcnt(7)
    v_mfma_f32_16x16x32_bf16 v[144:147], a[224:227], v[72:75], 0
    s_waitcnt lgkmcnt(6)
    v_mfma_f32_16x16x32_bf16 v[144:147], a[232:235], v[88:91], v[144:147]
    s_add_u32 m0, s68, 77824
    s_add_u32 s66, s66, 0x40000
    buffer_load_dwordx4 v1, s[20:23], s66 offen  lds
    v_mfma_f32_16x16x32_bf16 v[148:151], a[236:239], v[88:91], 0
    v_mfma_f32_16x16x32_bf16 v[148:151], a[228:231], v[72:75], v[148:151]
    s_add_u32 m0, s68, 81920
    s_add_u32 s66, s66, 0x40000
    buffer_load_dwordx4 v1, s[20:23], s66 offen  lds
    s_waitcnt lgkmcnt(5)
    v_mfma_f32_16x16x32_bf16 v[156:159], a[228:231], v[76:79], 0
    s_waitcnt lgkmcnt(4)
    v_mfma_f32_16x16x32_bf16 v[156:159], a[236:239], v[92:95], v[156:159]
    s_add_u32 m0, s68, 86016
    s_add_u32 s66, s66, 0x40000
    buffer_load_dwordx4 v1, s[20:23], s66 offen  lds
    v_mfma_f32_16x16x32_bf16 v[152:155], a[232:235], v[92:95], 0
    v_mfma_f32_16x16x32_bf16 v[152:155], a[224:227], v[76:79], v[152:155]
    s_add_u32 m0, s68, 90112
    s_add_u32 s66, s66, 0x40000
    buffer_load_dwordx4 v1, s[20:23], s66 offen  lds
    s_add_u32 s6, s60, 2
    s_and_b32 s6, s6, 3
    s_lshl_b32 s82, s6, 7
    s_mul_i32 s86, s6, 57344
    s_add_u32 s6, s60, 3
    s_and_b32 s6, s6, 3
    s_lshl_b32 s83, s6, 7
    s_mul_i32 s87, s6, 57344
    v_lshrrev_b32 v100, 2, v0
    v_bfe_u32 v101, v0, 3, 2
    v_and_b32 v102, 3, v0
    v_xor_b32 v103, s58, v101
    v_lshl_add_u32 v103, v103, 2, v102
    v_lshl_add_u32 v103, v100, 4, v103
    s_add_u32 s6, s67, 0x10000
    v_lshl_add_u32 v15, v103, 3, s6
    v_xor_b32 v16, 4096, v15
    v_xor_b32 v17, 8192, v15
    v_xor_b32 v18, 12288, v15
    v_mul_u32_u24 v100, 896, v100
    v_lshl_add_u32 v100, v102, 3, v100
    s_mul_i32 s6, s58, 7
    v_xor_b32 v103, s6, v101
    v_lshl_add_u32 v19, v103, 5, v100
    s_add_u32 s6, s6, 1
    v_xor_b32 v103, s6, v101
    v_lshl_add_u32 v20, v103, 5, v100
    s_add_u32 s6, s6, 1
    v_xor_b32 v103, s6, v101
    v_lshl_add_u32 v21, v103, 5, v100
    s_add_u32 s6, s6, 1
    v_xor_b32 v103, s6, v101
    v_lshl_add_u32 v22, v103, 5, v100
    v_add_u32 v23, s67, v29
    v_xor_b32 v24, 4096, v23
    v_xor_b32 v25, 8192, v23
    v_xor_b32 v26, 12288, v23
    s_mul_i32 s6, s58, 14336
    v_lshl_add_u32 v31, v0, 4, s6
    s_waitcnt vmcnt(11) lgkmcnt(0)
    v_mfma_f32_16x16x32_bf16 v[160:163], a[240:243], v[64:67], 0
    ds_read_b128 a[224:227], v13 offset:32768
    ds_read_b128 a[228:231], v13 offset:34816
    v_mfma_f32_16x16x32_bf16 v[160:163], a[248:251], v[80:83], v[160:163]
    ds_read_b128 a[232:235], v14 offset:32768
    ds_read_b128 a[236:239], v14 offset:34816
    v_mfma_f32_16x16x32_bf16 v[164:167], a[252:255], v[80:83], 0
    s_add_u32 m0, s68, 98304
    s_add_u32 s66, s75, s81
    buffer_load_dwordx4 v1, s[20:23], s66 offen  lds
    v_mfma_f32_16x16x32_bf16 v[164:167], a[244:247], v[64:67], v[164:167]
    v_mfma_f32_16x16x32_bf16 v[172:175], a[244:247], v[68:71], 0
    v_mfma_f32_16x16x32_bf16 v[172:175], a[252:255], v[84:87], v[172:175]
    v_mfma_f32_16x16x32_bf16 v[168:171], a[248:251], v[84:87], 0
    s_add_u32 m0, s68, 102400
    s_add_u32 s66, s66, 0x40000
    buffer_load_dwordx4 v1, s[20:23], s66 offen  lds
    v_mfma_f32_16x16x32_bf16 v[168:171], a[240:243], v[68:71], v[168:171]
    v_mfma_f32_16x16x32_bf16 v[176:179], a[240:243], v[72:75], 0
    v_mfma_f32_16x16x32_bf16 v[176:179], a[248:251], v[88:91], v[176:179]
    v_mfma_f32_16x16x32_bf16 v[180:183], a[252:255], v[88:91], 0
    s_add_u32 m0, s68, 106496
    s_add_u32 s66, s66, 0x40000
    buffer_load_dwordx4 v1, s[20:23], s66 offen  lds
    v_mfma_f32_16x16x32_bf16 v[180:183], a[244:247], v[72:75], v[180:183]
    v_mfma_f32_16x16x32_bf16 v[188:191], a[244:247], v[76:79], 0
    v_mfma_f32_16x16x32_bf16 v[188:191], a[252:255], v[92:95], v[188:191]
    v_mfma_f32_16x16x32_bf16 v[184:187], a[248:251], v[92:95], 0
    s_add_u32 m0, s68, 110592
    s_add_u32 s66, s66, 0x40000
    buffer_load_dwordx4 v1, s[20:23], s66 offen  lds
    v_mfma_f32_16x16x32_bf16 v[184:187], a[240:243], v[76:79], v[184:187]
    s_waitcnt vmcnt(11) lgkmcnt(0)
    v_mfma_f32_16x16x32_bf16 v[192:195], a[224:227], v[64:67], 0
    s_add_u32 m0, s68, 114688
    s_add_u32 s66, s66, 0x40000
    buffer_load_dwordx4 v1, s[20:23], s66 offen  lds
    v_mfma_f32_16x16x32_bf16 v[192:195], a[232:235], v[80:83], v[192:195]
    ds_read_b128 a[240:243], v13 offset:49152
    ds_read_b128 a[244:247], v13 offset:51200
    v_mfma_f32_16x16x32_bf16 v[196:199], a[236:239], v[80:83], 0
    s_add_u32 m0, s68, 118784
    s_add_u32 s66, s66, 0x40000
    buffer_load_dwordx4 v1, s[20:23], s66 offen  lds
    v_mfma_f32_16x16x32_bf16 v[196:199], a[228:231], v[64:67], v[196:199]
    ds_read_b128 a[248:251], v14 offset:49152
    ds_read_b128 a[252:255], v14 offset:51200
    v_mfma_f32_16x16x32_bf16 v[204:207], a[228:231], v[68:71], 0
    s_add_u32 m0, s68, 122880
    s_add_u32 s66, s66, 0x40000
    buffer_load_dwordx4 v1, s[20:23], s66 offen  lds
    v_mfma_f32_16x16x32_bf16 v[204:207], a[236:239], v[84:87], v[204:207]
    v_mfma_f32_16x16x32_bf16 v[200:203], a[232:235], v[84:87], 0
    v_mfma_f32_16x16x32_bf16 v[200:203], a[224:227], v[68:71], v[200:203]
    v_mfma_f32_16x16x32_bf16 v[208:211], a[224:227], v[72:75], 0
    v_mfma_f32_16x16x32_bf16 v[208:211], a[232:235], v[88:91], v[208:211]
    s_add_u32 m0, s67, 0
    s_add_u32 s66, s81, 0
    buffer_load_dwordx4 v2, s[12:15], s66 offen offset:0 nt lds
    v_mfma_f32_16x16x32_bf16 v[212:215], a[236:239], v[88:91], 0
    v_mfma_f32_16x16x32_bf16 v[212:215], a[228:231], v[72:75], v[212:215]
    buffer_load_dwordx4 v3, s[12:15], s66 offen offset:1024 nt lds
    v_mfma_f32_16x16x32_bf16 v[220:223], a[228:231], v[76:79], 0
    v_mfma_f32_16x16x32_bf16 v[220:223], a[236:239], v[92:95], v[220:223]
    buffer_load_dwordx4 v2, s[12:15], s66 offen offset:2048 nt lds
    v_mfma_f32_16x16x32_bf16 v[216:219], a[232:235], v[92:95], 0
    v_mfma_f32_16x16x32_bf16 v[216:219], a[224:227], v[76:79], v[216:219]
    buffer_load_dwordx4 v3, s[12:15], s66 offen offset:3072 nt lds
    v_mov_b32 v36, 0
    buffer_store_dword v36, v37, s[32:35], 0 offen sc1
    s_waitcnt vmcnt(14) lgkmcnt(0)
    s_barrier
    v_mfma_f32_16x16x32_bf16 v[224:227], a[240:243], v[64:67], 0
    ds_read_b64_tr_b16 a[224:225], v12 offset:0
    ds_read_b64_tr_b16 a[226:227], v12 offset:512
    v_mfma_f32_16x16x32_bf16 v[224:227], a[248:251], v[80:83], v[224:227]
    ds_read_b64_tr_b16 a[228:229], v12 offset:4096
    ds_read_b64_tr_b16 a[230:231], v12 offset:4608
    v_mfma_f32_16x16x32_bf16 v[228:231], a[252:255], v[80:83], 0
    ds_read_b64_tr_b16 a[232:233], v12 offset:8192
    ds_read_b64_tr_b16 a[234:235], v12 offset:8704
    v_mfma_f32_16x16x32_bf16 v[228:231], a[244:247], v[64:67], v[228:231]
    ds_read_b64_tr_b16 a[236:237], v12 offset:12288
    ds_read_b64_tr_b16 a[238:239], v12 offset:12800
    v_mfma_f32_16x16x32_bf16 v[236:239], a[244:247], v[68:71], 0
    v_mfma_f32_16x16x32_bf16 v[236:239], a[252:255], v[84:87], v[236:239]
    v_mfma_f32_16x16x32_bf16 v[232:235], a[248:251], v[84:87], 0
    s_add_u32 m0, s67, 16384
    s_add_u32 s66, s81, 65536
    buffer_load_dwordx4 v2, s[12:15], s66 offen offset:0 nt lds
    v_mfma_f32_16x16x32_bf16 v[232:235], a[240:243], v[68:71], v[232:235]
    v_mfma_f32_16x16x32_bf16 v[240:243], a[240:243], v[72:75], 0
    v_mfma_f32_16x16x32_bf16 v[240:243], a[248:251], v[88:91], v[240:243]
    buffer_load_dwordx4 v3, s[12:15], s66 offen offset:1024 nt lds
    v_mfma_f32_16x16x32_bf16 v[244:247], a[252:255], v[88:91], 0
    v_mfma_f32_16x16x32_bf16 v[244:247], a[244:247], v[72:75], v[244:247]
    v_mfma_f32_16x16x32_bf16 v[252:255], a[244:247], v[76:79], 0
    buffer_load_dwordx4 v2, s[12:15], s66 offen offset:2048 nt lds
    v_mfma_f32_16x16x32_bf16 v[252:255], a[252:255], v[92:95], v[252:255]
    v_mfma_f32_16x16x32_bf16 v[248:251], a[248:251], v[92:95], 0
    v_mfma_f32_16x16x32_bf16 v[248:251], a[240:243], v[76:79], v[248:251]
    buffer_load_dwordx4 v3, s[12:15], s66 offen offset:3072 nt lds
    s_waitcnt vmcnt(15) lgkmcnt(0)
    s_barrier
    v_mfma_f32_16x16x32_bf16 v[48:51], a[224:227], a[0:3], 0
    ds_read_b64_tr_b16 a[240:241], v12 offset:16384
    ds_read_b64_tr_b16 a[242:243], v12 offset:16896
    v_mfma_f32_16x16x32_bf16 v[48:51], a[228:231], a[16:19], v[48:51]
    ds_read_b64_tr_b16 a[244:245], v12 offset:20480
    ds_read_b64_tr_b16 a[246:247], v12 offset:20992
    v_mfma_f32_16x16x32_bf16 v[48:51], a[232:235], a[32:35], v[48:51]
    ds_read_b64_tr_b16 a[248:249], v12 offset:24576
    ds_read_b64_tr_b16 a[250:251], v12 offset:25088
    v_mfma_f32_16x16x32_bf16 v[48:51], a[236:239], a[48:51], v[48:51]
    v_mfma_f32_16x16x32_bf16 v[52:55], a[236:239], a[52:55], 0
    v_mfma_f32_16x16x32_bf16 v[52:55], a[232:235], a[36:39], v[52:55]
    v_mfma_f32_16x16x32_bf16 v[52:55], a[228:231], a[20:23], v[52:55]
    s_add_u32 m0, s67, 32768
    s_add_u32 s66, s81, 131072
    buffer_load_dwordx4 v2, s[12:15], s66 offen offset:0 nt lds
    v_mfma_f32_16x16x32_bf16 v[52:55], a[224:227], a[4:7], v[52:55]
    v_mfma_f32_16x16x32_bf16 v[56:59], a[224:227], a[8:11], 0
    v_mfma_f32_16x16x32_bf16 v[56:59], a[228:231], a[24:27], v[56:59]
    buffer_load_dwordx4 v3, s[12:15], s66 offen offset:1024 nt lds
    v_mfma_f32_16x16x32_bf16 v[56:59], a[232:235], a[40:43], v[56:59]
    v_mfma_f32_16x16x32_bf16 v[56:59], a[236:239], a[56:59], v[56:59]
    v_mfma_f32_16x16x32_bf16 v[60:63], a[236:239], a[60:63], 0
    buffer_load_dwordx4 v2, s[12:15], s66 offen offset:2048 nt lds
    v_mfma_f32_16x16x32_bf16 v[60:63], a[232:235], a[44:47], v[60:63]
    v_mfma_f32_16x16x32_bf16 v[60:63], a[228:231], a[28:31], v[60:63]
    v_mfma_f32_16x16x32_bf16 v[60:63], a[224:227], a[12:15], v[60:63]
    buffer_load_dwordx4 v3, s[12:15], s66 offen offset:3072 nt lds
    s_waitcnt vmcnt(15) lgkmcnt(0)
    s_barrier
    v_mfma_f32_16x16x32_bf16 v[48:51], a[240:243], a[64:67], v[48:51]
    ds_read_b64_tr_b16 a[224:225], v12 offset:32768
    ds_read_b64_tr_b16 a[226:227], v12 offset:33280
    v_mfma_f32_16x16x32_bf16 v[48:51], a[244:247], a[80:83], v[48:51]
    ds_read_b64_tr_b16 a[228:229], v12 offset:36864
    ds_read_b64_tr_b16 a[230:231], v12 offset:37376
    v_mfma_f32_16x16x32_bf16 v[48:51], a[248:251], a[96:99], v[48:51]
    ds_read_b64_tr_b16 a[232:233], v12 offset:40960
    ds_read_b64_tr_b16 a[234:235], v12 offset:41472
    v_mfma_f32_16x16x32_bf16 v[52:55], a[248:251], a[100:103], v[52:55]
    ds_read_b64_tr_b16 a[236:237], v12 offset:45056
    ds_read_b64_tr_b16 a[238:239], v12 offset:45568
    v_mfma_f32_16x16x32_bf16 v[52:55], a[244:247], a[84:87], v[52:55]
    v_mfma_f32_16x16x32_bf16 v[52:55], a[240:243], a[68:71], v[52:55]
    v_mfma_f32_16x16x32_bf16 v[56:59], a[240:243], a[72:75], v[56:59]
    v_mfma_f32_16x16x32_bf16 v[56:59], a[244:247], a[88:91], v[56:59]
    v_mfma_f32_16x16x32_bf16 v[56:59], a[248:251], a[104:107], v[56:59]
    v_mfma_f32_16x16x32_bf16 v[60:63], a[248:251], a[108:111], v[60:63]
    v_mfma_f32_16x16x32_bf16 v[60:63], a[244:247], a[92:95], v[60:63]
    v_mfma_f32_16x16x32_bf16 v[60:63], a[240:243], a[76:79], v[60:63]
    s_waitcnt vmcnt(12) lgkmcnt(0)
    s_barrier
    v_mfma_f32_16x16x32_bf16 v[48:51], a[224:227], a[112:115], v[48:51]
    ds_read_b64_tr_b16 a[240:241], v12 offset:49152
    ds_read_b64_tr_b16 a[242:243], v12 offset:49664
    v_mfma_f32_16x16x32_bf16 v[48:51], a[228:231], a[128:131], v[48:51]
    ds_read_b64_tr_b16 a[244:245], v12 offset:53248
    ds_read_b64_tr_b16 a[246:247], v12 offset:53760
    v_mfma_f32_16x16x32_bf16 v[48:51], a[232:235], a[144:147], v[48:51]
    ds_read_b64_tr_b16 a[248:249], v12 offset:57344
    ds_read_b64_tr_b16 a[250:251], v12 offset:57856
    v_mfma_f32_16x16x32_bf16 v[48:51], a[236:239], a[160:163], v[48:51]
    v_mfma_f32_16x16x32_bf16 v[52:55], a[236:239], a[164:167], v[52:55]
    v_mfma_f32_16x16x32_bf16 v[52:55], a[232:235], a[148:151], v[52:55]
    v_mfma_f32_16x16x32_bf16 v[52:55], a[228:231], a[132:135], v[52:55]
    v_mfma_f32_16x16x32_bf16 v[52:55], a[224:227], a[116:119], v[52:55]
    v_mfma_f32_16x16x32_bf16 v[56:59], a[224:227], a[120:123], v[56:59]
    v_mfma_f32_16x16x32_bf16 v[56:59], a[228:231], a[136:139], v[56:59]
    v_mfma_f32_16x16x32_bf16 v[56:59], a[232:235], a[152:155], v[56:59]
    v_mfma_f32_16x16x32_bf16 v[56:59], a[236:239], a[168:171], v[56:59]
    v_mfma_f32_16x16x32_bf16 v[60:63], a[236:239], a[172:175], v[60:63]
    v_mfma_f32_16x16x32_bf16 v[60:63], a[232:235], a[156:159], v[60:63]
    v_mfma_f32_16x16x32_bf16 v[60:63], a[228:231], a[140:143], v[60:63]
    v_mfma_f32_16x16x32_bf16 v[60:63], a[224:227], a[124:127], v[60:63]
    s_add_u32 m0, s67, 49152
    s_add_u32 s66, s81, 196608
    buffer_load_dwordx4 v2, s[12:15], s66 offen offset:0 nt lds
    buffer_load_dwordx4 v3, s[12:15], s66 offen offset:1024 nt lds
    buffer_load_dwordx4 v2, s[12:15], s66 offen offset:2048 nt lds
    buffer_load_dwordx4 v3, s[12:15], s66 offen offset:3072 nt lds
    s_waitcnt vmcnt(12) lgkmcnt(0)
    v_mfma_f32_16x16x32_bf16 v[48:51], a[240:243], a[176:179], v[48:51]
    ds_read_b128 a[224:227], v13 offset:0
    ds_read_b128 a[228:231], v13 offset:2048
    v_mfma_f32_16x16x32_bf16 v[48:51], a[244:247], a[192:195], v[48:51]
    ds_read_b128 a[232:235], v14 offset:0
    ds_read_b128 a[236:239], v14 offset:2048
    v_mfma_f32_16x16x32_bf16 v[48:51], a[248:251], a[208:211], v[48:51]
    v_mfma_f32_16x16x32_bf16 v[52:55], a[248:251], a[212:215], v[52:55]
    v_mfma_f32_16x16x32_bf16 v[52:55], a[244:247], a[196:199], v[52:55]
    v_mfma_f32_16x16x32_bf16 v[52:55], a[240:243], a[180:183], v[52:55]
    v_mfma_f32_16x16x32_bf16 v[56:59], a[240:243], a[184:187], v[56:59]
    v_mfma_f32_16x16x32_bf16 v[56:59], a[244:247], a[200:203], v[56:59]
    v_mfma_f32_16x16x32_bf16 v[56:59], a[248:251], a[216:219], v[56:59]
    v_mfma_f32_16x16x32_bf16 v[60:63], a[248:251], a[220:223], v[60:63]
    v_mfma_f32_16x16x32_bf16 v[60:63], a[244:247], a[204:207], v[60:63]
    v_mfma_f32_16x16x32_bf16 v[60:63], a[240:243], a[188:191], v[60:63]
    s_add_u32 m0, s68, 65536
    s_add_u32 s66, s74, s82
    buffer_load_dwordx4 v1, s[20:23], s66 offen  lds
    s_add_u32 m0, s68, 69632
    s_add_u32 s66, s66, 0x40000
    buffer_load_dwordx4 v1, s[20:23], s66 offen  lds
    s_add_u32 m0, s68, 73728
    s_add_u32 s66, s66, 0x40000
    buffer_load_dwordx4 v1, s[20:23], s66 offen  lds
    s_add_u32 m0, s68, 77824
    s_add_u32 s66, s66, 0x40000
    buffer_load_dwordx4 v1, s[20:23], s66 offen  lds
    v_cvt_pk_bf16_f32 v40, v48, v49
    v_cvt_pk_bf16_f32 v41, v50, v51
    v_cvt_pk_bf16_f32 v42, v52, v53
    v_cvt_pk_bf16_f32 v43, v54, v55
    v_cvt_pk_bf16_f32 v44, v56, v57
    v_cvt_pk_bf16_f32 v45, v58, v59
    v_cvt_pk_bf16_f32 v46, v60, v61
    v_cvt_pk_bf16_f32 v47, v62, v63
    ds_write_b64 v27, v[40:41] offset:0
    ds_write_b64 v27, v[42:43] offset:1024
    ds_write_b64 v27, v[44:45] offset:2048
    ds_write_b64 v27, v[46:47] offset:3072
    s_waitcnt vmcnt(12) lgkmcnt(0)
    s_barrier
    ds_read_b128 v[64:67], v29 offset:0
    ds_read_b128 v[80:83], v29 offset:4096
    ds_read_b128 v[68:71], v29 offset:1024
    ds_read_b128 v[84:87], v29 offset:5120
    ds_read_b128 v[72:75], v29 offset:2048
    ds_read_b128 v[88:91], v29 offset:6144
    ds_read_b128 v[76:79], v29 offset:3072
    ds_read_b128 v[92:95], v29 offset:7168
    s_waitcnt lgkmcnt(7)
    v_mfma_f32_16x16x32_bf16 v[128:131], a[224:227], v[64:67], v[128:131]
    ds_read_b128 a[240:243], v13 offset:16384
    ds_read_b128 a[244:247], v13 offset:18432
    s_waitcnt lgkmcnt(8)
    v_mfma_f32_16x16x32_bf16 v[128:131], a[232:235], v[80:83], v[128:131]
    ds_read_b128 a[248:251], v14 offset:16384
    ds_read_b128 a[252:255], v14 offset:18432
    v_mfma_f32_16x16x32_bf16 v[132:135], a[236:239], v[80:83], v[132:135]
    v_mfma_f32_16x16x32_bf16 v[132:135], a[228:231], v[64:67], v[132:135]
    s_waitcnt lgkmcnt(9)
    v_mfma_f32_16x16x32_bf16 v[140:143], a[228:231], v[68:71], v[140:143]
    s_waitcnt lgkmcnt(8)
    v_mfma_f32_16x16x32_bf16 v[140:143], a[236:239], v[84:87], v[140:143]
    v_mfma_f32_16x16x32_bf16 v[136:139], a[232:235], v[84:87], v[136:139]
    v_mfma_f32_16x16x32_bf16 v[136:139], a[224:227], v[68:71], v[136:139]
    s_waitcnt lgkmcnt(7)
    v_mfma_f32_16x16x32_bf16 v[144:147], a[224:227], v[72:75], v[144:147]
    s_waitcnt lgkmcnt(6)
    v_mfma_f32_16x16x32_bf16 v[144:147], a[232:235], v[88:91], v[144:147]
    s_add_u32 m0, s68, 81920
    s_add_u32 s66, s66, 0x40000
    buffer_load_dwordx4 v1, s[20:23], s66 offen  lds
    v_mfma_f32_16x16x32_bf16 v[148:151], a[236:239], v[88:91], v[148:151]
    v_mfma_f32_16x16x32_bf16 v[148:151], a[228:231], v[72:75], v[148:151]
    s_waitcnt lgkmcnt(5)
    v_mfma_f32_16x16x32_bf16 v[156:159], a[228:231], v[76:79], v[156:159]
    s_add_u32 m0, s68, 86016
    s_add_u32 s66, s66, 0x40000
    buffer_load_dwordx4 v1, s[20:23], s66 offen  lds
    s_waitcnt lgkmcnt(4)
    v_mfma_f32_16x16x32_bf16 v[156:159], a[236:239], v[92:95], v[156:159]
    v_mfma_f32_16x16x32_bf16 v[152:155], a[232:235], v[92:95], v[152:155]
    v_mfma_f32_16x16x32_bf16 v[152:155], a[224:227], v[76:79], v[152:155]
    s_add_u32 m0, s68, 90112
    s_add_u32 s66, s66, 0x40000
    buffer_load_dwordx4 v1, s[20:23], s66 offen  lds
    s_mov_b32 s70, 0x3db8aa3b
    s_mov_b32 s71, 0x3db8aa3b
    s_mul_i32 s76, s62, 28672
    s_sub_u32 s77, 28672, s76
    v_lshl_add_u32 v101, v0, 4, s68
    v_add_u32 v102, 0, v101
    v_lshrrev_b32 v103, 8, v102
    v_mul_u32_u24 v103, 147, v103
    v_bfe_u32 v103, v103, 10, 2
    v_lshlrev_b32 v103, 5, v103
    v_xor_b32 v5, v103, v102
    v_add_u32 v102, 4096, v101
    v_lshrrev_b32 v103, 8, v102
    v_mul_u32_u24 v103, 147, v103
    v_bfe_u32 v103, v103, 10, 2
    v_lshlrev_b32 v103, 5, v103
    v_xor_b32 v6, v103, v102
    v_add_u32 v102, 8192, v101
    v_lshrrev_b32 v103, 8, v102
    v_mul_u32_u24 v103, 147, v103
    v_bfe_u32 v103, v103, 10, 2
    v_lshlrev_b32 v103, 5, v103
    v_xor_b32 v7, v103, v102
    v_add_u32 v102, 12288, v101
    v_lshrrev_b32 v103, 8, v102
    v_mul_u32_u24 v103, 147, v103
    v_bfe_u32 v103, v103, 10, 2
    v_lshlrev_b32 v103, 5, v103
    v_xor_b32 v8, v103, v102
    v_add_u32 v102, 16384, v101
    v_lshrrev_b32 v103, 8, v102
    v_mul_u32_u24 v103, 147, v103
    v_bfe_u32 v103, v103, 10, 2
    v_lshlrev_b32 v103, 5, v103
    v_xor_b32 v9, v103, v102
    v_add_u32 v102, 20480, v101
    v_lshrrev_b32 v103, 8, v102
    v_mul_u32_u24 v103, 147, v103
    v_bfe_u32 v103, v103, 10, 2
    v_lshlrev_b32 v103, 5, v103
    v_xor_b32 v10, v103, v102
    v_add_u32 v102, 24576, v101
    v_lshrrev_b32 v103, 8, v102
    v_mul_u32_u24 v103, 147, v103
    v_bfe_u32 v103, v103, 10, 2
    v_lshlrev_b32 v103, 5, v103
    v_xor_b32 v11, v103, v102
    s_waitcnt vmcnt(11) lgkmcnt(0)
    v_mfma_f32_16x16x32_bf16 v[160:163], a[240:243], v[64:67], v[160:163]
    ds_read_b128 a[224:227], v13 offset:32768
    ds_read_b128 a[228:231], v13 offset:34816
    v_mfma_f32_16x16x32_bf16 v[160:163], a[248:251], v[80:83], v[160:163]
    ds_read_b128 a[232:235], v14 offset:32768
    ds_read_b128 a[236:239], v14 offset:34816
    v_mfma_f32_16x16x32_bf16 v[164:167], a[252:255], v[80:83], v[164:167]
    s_add_u32 m0, s68, 98304
    s_add_u32 s66, s75, s82
    buffer_load_dwordx4 v1, s[20:23], s66 offen  lds
    v_mfma_f32_16x16x32_bf16 v[164:167], a[244:247], v[64:67], v[164:167]
    v_mfma_f32_16x16x32_bf16 v[172:175], a[244:247], v[68:71], v[172:175]
    v_mfma_f32_16x16x32_bf16 v[172:175], a[252:255], v[84:87], v[172:175]
    v_mfma_f32_16x16x32_bf16 v[168:171], a[248:251], v[84:87], v[168:171]
    s_add_u32 m0, s68, 102400
    s_add_u32 s66, s66, 0x40000
    buffer_load_dwordx4 v1, s[20:23], s66 offen  lds
    v_mfma_f32_16x16x32_bf16 v[168:171], a[240:243], v[68:71], v[168:171]
    v_mfma_f32_16x16x32_bf16 v[176:179], a[240:243], v[72:75], v[176:179]
    v_mfma_f32_16x16x32_bf16 v[176:179], a[248:251], v[88:91], v[176:179]
    v_mfma_f32_16x16x32_bf16 v[180:183], a[252:255], v[88:91], v[180:183]
    s_add_u32 m0, s68, 106496
    s_add_u32 s66, s66, 0x40000
    buffer_load_dwordx4 v1, s[20:23], s66 offen  lds
    v_mfma_f32_16x16x32_bf16 v[180:183], a[244:247], v[72:75], v[180:183]
    v_mfma_f32_16x16x32_bf16 v[188:191], a[244:247], v[76:79], v[188:191]
    v_mfma_f32_16x16x32_bf16 v[188:191], a[252:255], v[92:95], v[188:191]
    v_mfma_f32_16x16x32_bf16 v[184:187], a[248:251], v[92:95], v[184:187]
    s_add_u32 m0, s68, 110592
    s_add_u32 s66, s66, 0x40000
    buffer_load_dwordx4 v1, s[20:23], s66 offen  lds
    v_mfma_f32_16x16x32_bf16 v[184:187], a[240:243], v[76:79], v[184:187]
    s_waitcnt vmcnt(11) lgkmcnt(0)
    v_mfma_f32_16x16x32_bf16 v[192:195], a[224:227], v[64:67], v[192:195]
    s_add_u32 m0, s68, 114688
    s_add_u32 s66, s66, 0x40000
    buffer_load_dwordx4 v1, s[20:23], s66 offen  lds
    v_mfma_f32_16x16x32_bf16 v[192:195], a[232:235], v[80:83], v[192:195]
    ds_read_b128 a[240:243], v13 offset:49152
    ds_read_b128 a[244:247], v13 offset:51200
    v_mfma_f32_16x16x32_bf16 v[196:199], a[236:239], v[80:83], v[196:199]
    s_add_u32 m0, s68, 118784
    s_add_u32 s66, s66, 0x40000
    buffer_load_dwordx4 v1, s[20:23], s66 offen  lds
    v_mfma_f32_16x16x32_bf16 v[196:199], a[228:231], v[64:67], v[196:199]
    ds_read_b128 a[248:251], v14 offset:49152
    ds_read_b128 a[252:255], v14 offset:51200
    v_mfma_f32_16x16x32_bf16 v[204:207], a[228:231], v[68:71], v[204:207]
    s_add_u32 m0, s68, 122880
    s_add_u32 s66, s66, 0x40000
    buffer_load_dwordx4 v1, s[20:23], s66 offen  lds
    v_mfma_f32_16x16x32_bf16 v[204:207], a[236:239], v[84:87], v[204:207]
    v_mfma_f32_16x16x32_bf16 v[200:203], a[232:235], v[84:87], v[200:203]
    v_mfma_f32_16x16x32_bf16 v[200:203], a[224:227], v[68:71], v[200:203]
    v_mfma_f32_16x16x32_bf16 v[208:211], a[224:227], v[72:75], v[208:211]
    v_mfma_f32_16x16x32_bf16 v[208:211], a[232:235], v[88:91], v[208:211]
    s_add_u32 m0, s67, 0
    s_add_u32 s66, s82, 0
    buffer_load_dwordx4 v2, s[12:15], s66 offen offset:0 nt lds
    v_mfma_f32_16x16x32_bf16 v[212:215], a[236:239], v[88:91], v[212:215]
    v_mfma_f32_16x16x32_bf16 v[212:215], a[228:231], v[72:75], v[212:215]
    buffer_load_dwordx4 v3, s[12:15], s66 offen offset:1024 nt lds
    v_mfma_f32_16x16x32_bf16 v[220:223], a[228:231], v[76:79], v[220:223]
    v_mfma_f32_16x16x32_bf16 v[220:223], a[236:239], v[92:95], v[220:223]
    buffer_load_dwordx4 v2, s[12:15], s66 offen offset:2048 nt lds
    v_mfma_f32_16x16x32_bf16 v[216:219], a[232:235], v[92:95], v[216:219]
    v_mfma_f32_16x16x32_bf16 v[216:219], a[224:227], v[76:79], v[216:219]
    buffer_load_dwordx4 v3, s[12:15], s66 offen offset:3072 nt lds
    s_waitcnt vmcnt(14) lgkmcnt(0)
    s_barrier
    v_mfma_f32_16x16x32_bf16 v[224:227], a[240:243], v[64:67], v[224:227]
    ds_read_b64_tr_b16 a[224:225], v12 offset:0
    ds_read_b64_tr_b16 a[226:227], v12 offset:512
    v_mfma_f32_16x16x32_bf16 v[224:227], a[248:251], v[80:83], v[224:227]
    ds_read_b64_tr_b16 a[228:229], v12 offset:4096
    ds_read_b64_tr_b16 a[230:231], v12 offset:4608
    v_mfma_f32_16x16x32_bf16 v[228:231], a[252:255], v[80:83], v[228:231]
    ds_read_b64_tr_b16 a[232:233], v12 offset:8192
    ds_read_b64_tr_b16 a[234:235], v12 offset:8704
    v_mfma_f32_16x16x32_bf16 v[228:231], a[244:247], v[64:67], v[228:231]
    ds_read_b64_tr_b16 a[236:237], v12 offset:12288
    ds_read_b64_tr_b16 a[238:239], v12 offset:12800
    v_mfma_f32_16x16x32_bf16 v[236:239], a[244:247], v[68:71], v[236:239]
    v_mfma_f32_16x16x32_bf16 v[236:239], a[252:255], v[84:87], v[236:239]
    v_mfma_f32_16x16x32_bf16 v[232:235], a[248:251], v[84:87], v[232:235]
    s_add_u32 m0, s67, 16384
    s_add_u32 s66, s82, 65536
    buffer_load_dwordx4 v2, s[12:15], s66 offen offset:0 nt lds
    v_mfma_f32_16x16x32_bf16 v[232:235], a[240:243], v[68:71], v[232:235]
    v_mfma_f32_16x16x32_bf16 v[240:243], a[240:243], v[72:75], v[240:243]
    v_mfma_f32_16x16x32_bf16 v[240:243], a[248:251], v[88:91], v[240:243]
    buffer_load_dwordx4 v3, s[12:15], s66 offen offset:1024 nt lds
    v_mfma_f32_16x16x32_bf16 v[244:247], a[252:255], v[88:91], v[244:247]
    v_mfma_f32_16x16x32_bf16 v[244:247], a[244:247], v[72:75], v[244:247]
    v_mfma_f32_16x16x32_bf16 v[252:255], a[244:247], v[76:79], v[252:255]
    buffer_load_dwordx4 v2, s[12:15], s66 offen offset:2048 nt lds
    v_mfma_f32_16x16x32_bf16 v[252:255], a[252:255], v[92:95], v[252:255]
    v_mfma_f32_16x16x32_bf16 v[248:251], a[248:251], v[92:95], v[248:251]
    v_mfma_f32_16x16x32_bf16 v[248:251], a[240:243], v[76:79], v[248:251]
    buffer_load_dwordx4 v3, s[12:15], s66 offen offset:3072 nt lds
    s_waitcnt vmcnt(15) lgkmcnt(0)
    s_barrier
    v_mfma_f32_16x16x32_bf16 v[48:51], a[224:227], a[0:3], 0
    ds_read_b64_tr_b16 a[240:241], v12 offset:16384
    ds_read_b64_tr_b16 a[242:243], v12 offset:16896
    v_mfma_f32_16x16x32_bf16 v[48:51], a[228:231], a[16:19], v[48:51]
    ds_read_b64_tr_b16 a[244:245], v12 offset:20480
    ds_read_b64_tr_b16 a[246:247], v12 offset:20992
    v_mfma_f32_16x16x32_bf16 v[48:51], a[232:235], a[32:35], v[48:51]
    ds_read_b64_tr_b16 a[248:249], v12 offset:24576
    ds_read_b64_tr_b16 a[250:251], v12 offset:25088
    v_mfma_f32_16x16x32_bf16 v[48:51], a[236:239], a[48:51], v[48:51]
    v_mfma_f32_16x16x32_bf16 v[52:55], a[236:239], a[52:55], 0
    v_mfma_f32_16x16x32_bf16 v[52:55], a[232:235], a[36:39], v[52:55]
    v_mfma_f32_16x16x32_bf16 v[52:55], a[228:231], a[20:23], v[52:55]
    s_add_u32 m0, s67, 32768
    s_add_u32 s66, s82, 131072
    buffer_load_dwordx4 v2, s[12:15], s66 offen offset:0 nt lds
    v_mfma_f32_16x16x32_bf16 v[52:55], a[224:227], a[4:7], v[52:55]
    v_mfma_f32_16x16x32_bf16 v[56:59], a[224:227], a[8:11], 0
    v_mfma_f32_16x16x32_bf16 v[56:59], a[228:231], a[24:27], v[56:59]
    buffer_load_dwordx4 v3, s[12:15], s66 offen offset:1024 nt lds
    v_mfma_f32_16x16x32_bf16 v[56:59], a[232:235], a[40:43], v[56:59]
    v_mfma_f32_16x16x32_bf16 v[56:59], a[236:239], a[56:59], v[56:59]
    v_mfma_f32_16x16x32_bf16 v[60:63], a[236:239], a[60:63], 0
    buffer_load_dwordx4 v2, s[12:15], s66 offen offset:2048 nt lds
    v_mfma_f32_16x16x32_bf16 v[60:63], a[232:235], a[44:47], v[60:63]
    v_mfma_f32_16x16x32_bf16 v[60:63], a[228:231], a[28:31], v[60:63]
    v_mfma_f32_16x16x32_bf16 v[60:63], a[224:227], a[12:15], v[60:63]
    buffer_load_dwordx4 v3, s[12:15], s66 offen offset:3072 nt lds
    s_waitcnt vmcnt(15) lgkmcnt(0)
    s_barrier
    v_mfma_f32_16x16x32_bf16 v[48:51], a[240:243], a[64:67], v[48:51]
    ds_read_b64_tr_b16 a[224:225], v12 offset:32768
    ds_read_b64_tr_b16 a[226:227], v12 offset:33280
    v_mfma_f32_16x16x32_bf16 v[48:51], a[244:247], a[80:83], v[48:51]
    ds_read_b64_tr_b16 a[228:229], v12 offset:36864
    ds_read_b64_tr_b16 a[230:231], v12 offset:37376
    v_mfma_f32_16x16x32_bf16 v[48:51], a[248:251], a[96:99], v[48:51]
    ds_read_b64_tr_b16 a[232:233], v12 offset:40960
    ds_read_b64_tr_b16 a[234:235], v12 offset:41472
    v_mfma_f32_16x16x32_bf16 v[52:55], a[248:251], a[100:103], v[52:55]
    ds_read_b64_tr_b16 a[236:237], v12 offset:45056
    ds_read_b64_tr_b16 a[238:239], v12 offset:45568
    v_mfma_f32_16x16x32_bf16 v[52:55], a[244:247], a[84:87], v[52:55]
    v_mfma_f32_16x16x32_bf16 v[52:55], a[240:243], a[68:71], v[52:55]
    v_mfma_f32_16x16x32_bf16 v[56:59], a[240:243], a[72:75], v[56:59]
    v_mfma_f32_16x16x32_bf16 v[56:59], a[244:247], a[88:91], v[56:59]
    v_mfma_f32_16x16x32_bf16 v[56:59], a[248:251], a[104:107], v[56:59]
    v_mfma_f32_16x16x32_bf16 v[60:63], a[248:251], a[108:111], v[60:63]
    v_mfma_f32_16x16x32_bf16 v[60:63], a[244:247], a[92:95], v[60:63]
    v_mfma_f32_16x16x32_bf16 v[60:63], a[240:243], a[76:79], v[60:63]
    s_waitcnt vmcnt(12) lgkmcnt(0)
    s_barrier
    v_mfma_f32_16x16x32_bf16 v[48:51], a[224:227], a[112:115], v[48:51]
    ds_read_b64_tr_b16 a[240:241], v12 offset:49152
    ds_read_b64_tr_b16 a[242:243], v12 offset:49664
    v_mfma_f32_16x16x32_bf16 v[48:51], a[228:231], a[128:131], v[48:51]
    ds_read_b64_tr_b16 a[244:245], v12 offset:53248
    ds_read_b64_tr_b16 a[246:247], v12 offset:53760
    v_mfma_f32_16x16x32_bf16 v[48:51], a[232:235], a[144:147], v[48:51]
    ds_read_b64_tr_b16 a[248:249], v12 offset:57344
    ds_read_b64_tr_b16 a[250:251], v12 offset:57856
    v_mfma_f32_16x16x32_bf16 v[48:51], a[236:239], a[160:163], v[48:51]
    v_mfma_f32_16x16x32_bf16 v[52:55], a[236:239], a[164:167], v[52:55]
    v_mfma_f32_16x16x32_bf16 v[52:55], a[232:235], a[148:151], v[52:55]
    v_mfma_f32_16x16x32_bf16 v[52:55], a[228:231], a[132:135], v[52:55]
    v_mfma_f32_16x16x32_bf16 v[52:55], a[224:227], a[116:119], v[52:55]
    v_mfma_f32_16x16x32_bf16 v[56:59], a[224:227], a[120:123], v[56:59]
    v_mfma_f32_16x16x32_bf16 v[56:59], a[228:231], a[136:139], v[56:59]
    v_mfma_f32_16x16x32_bf16 v[56:59], a[232:235], a[152:155], v[56:59]
    v_mfma_f32_16x16x32_bf16 v[56:59], a[236:239], a[168:171], v[56:59]
    v_mfma_f32_16x16x32_bf16 v[60:63], a[236:239], a[172:175], v[60:63]
    v_mfma_f32_16x16x32_bf16 v[60:63], a[232:235], a[156:159], v[60:63]
    v_mfma_f32_16x16x32_bf16 v[60:63], a[228:231], a[140:143], v[60:63]
    v_mfma_f32_16x16x32_bf16 v[60:63], a[224:227], a[124:127], v[60:63]
    s_add_u32 m0, s67, 49152
    s_add_u32 s66, s82, 196608
    buffer_load_dwordx4 v2, s[12:15], s66 offen offset:0 nt lds
    buffer_load_dwordx4 v3, s[12:15], s66 offen offset:1024 nt lds
    buffer_load_dwordx4 v2, s[12:15], s66 offen offset:2048 nt lds
    buffer_load_dwordx4 v3, s[12:15], s66 offen offset:3072 nt lds
    s_waitcnt vmcnt(12) lgkmcnt(0)
    v_mfma_f32_16x16x32_bf16 v[48:51], a[240:243], a[176:179], v[48:51]
    ds_read_b128 a[224:227], v13 offset:0
    ds_read_b128 a[228:231], v13 offset:2048
    v_mfma_f32_16x16x32_bf16 v[48:51], a[244:247], a[192:195], v[48:51]
    ds_read_b128 a[232:235], v14 offset:0
    ds_read_b128 a[236:239], v14 offset:2048
    v_mfma_f32_16x16x32_bf16 v[48:51], a[248:251], a[208:211], v[48:51]
    v_mfma_f32_16x16x32_bf16 v[52:55], a[248:251], a[212:215], v[52:55]
    v_mfma_f32_16x16x32_bf16 v[52:55], a[244:247], a[196:199], v[52:55]
    v_mfma_f32_16x16x32_bf16 v[52:55], a[240:243], a[180:183], v[52:55]
    v_mfma_f32_16x16x32_bf16 v[56:59], a[240:243], a[184:187], v[56:59]
    v_mfma_f32_16x16x32_bf16 v[56:59], a[244:247], a[200:203], v[56:59]
    v_mfma_f32_16x16x32_bf16 v[56:59], a[248:251], a[216:219], v[56:59]
    v_mfma_f32_16x16x32_bf16 v[60:63], a[248:251], a[220:223], v[60:63]
    v_mfma_f32_16x16x32_bf16 v[60:63], a[244:247], a[204:207], v[60:63]
    v_mfma_f32_16x16x32_bf16 v[60:63], a[240:243], a[188:191], v[60:63]
    s_add_u32 m0, s68, 65536
    s_add_u32 s66, s74, s83
    buffer_load_dwordx4 v1, s[20:23], s66 offen  lds
    s_add_u32 m0, s68, 69632
    s_add_u32 s66, s66, 0x40000
    buffer_load_dwordx4 v1, s[20:23], s66 offen  lds
    s_add_u32 m0, s68, 73728
    s_add_u32 s66, s66, 0x40000
    buffer_load_dwordx4 v1, s[20:23], s66 offen  lds
    s_add_u32 m0, s68, 77824
    s_add_u32 s66, s66, 0x40000
    buffer_load_dwordx4 v1, s[20:23], s66 offen  lds
    v_cvt_pk_bf16_f32 v40, v48, v49
    v_cvt_pk_bf16_f32 v41, v50, v51
    v_cvt_pk_bf16_f32 v42, v52, v53
    v_cvt_pk_bf16_f32 v43, v54, v55
    v_cvt_pk_bf16_f32 v44, v56, v57
    v_cvt_pk_bf16_f32 v45, v58, v59
    v_cvt_pk_bf16_f32 v46, v60, v61
    v_cvt_pk_bf16_f32 v47, v62, v63
    ds_write_b64 v27, v[40:41] offset:0
    ds_write_b64 v27, v[42:43] offset:1024
    ds_write_b64 v27, v[44:45] offset:2048
    ds_write_b64 v27, v[46:47] offset:3072
    s_waitcnt vmcnt(12) lgkmcnt(0)
    s_barrier
    ds_read_b128 v[64:67], v29 offset:0
    ds_read_b128 v[80:83], v29 offset:4096
    ds_read_b128 v[68:71], v29 offset:1024
    ds_read_b128 v[84:87], v29 offset:5120
    ds_read_b128 v[72:75], v29 offset:2048
    ds_read_b128 v[88:91], v29 offset:6144
    ds_read_b128 v[76:79], v29 offset:3072
    ds_read_b128 v[92:95], v29 offset:7168
    s_waitcnt lgkmcnt(7)
    v_mfma_f32_16x16x32_bf16 v[128:131], a[224:227], v[64:67], v[128:131]
    ds_read_b128 a[240:243], v13 offset:16384
    ds_read_b128 a[244:247], v13 offset:18432
    s_waitcnt lgkmcnt(8)
    v_mfma_f32_16x16x32_bf16 v[128:131], a[232:235], v[80:83], v[128:131]
    ds_read_b128 a[248:251], v14 offset:16384
    ds_read_b128 a[252:255], v14 offset:18432
    v_mfma_f32_16x16x32_bf16 v[132:135], a[236:239], v[80:83], v[132:135]
    v_mfma_f32_16x16x32_bf16 v[132:135], a[228:231], v[64:67], v[132:135]
    s_waitcnt lgkmcnt(9)
    v_mfma_f32_16x16x32_bf16 v[140:143], a[228:231], v[68:71], v[140:143]
    s_waitcnt lgkmcnt(8)
    v_mfma_f32_16x16x32_bf16 v[140:143], a[236:239], v[84:87], v[140:143]
    v_mfma_f32_16x16x32_bf16 v[136:139], a[232:235], v[84:87], v[136:139]
    v_mfma_f32_16x16x32_bf16 v[136:139], a[224:227], v[68:71], v[136:139]
    s_waitcnt lgkmcnt(7)
    v_mfma_f32_16x16x32_bf16 v[144:147], a[224:227], v[72:75], v[144:147]
    s_waitcnt lgkmcnt(6)
    v_mfma_f32_16x16x32_bf16 v[144:147], a[232:235], v[88:91], v[144:147]
    s_add_u32 m0, s68, 81920
    s_add_u32 s66, s66, 0x40000
    buffer_load_dwordx4 v1, s[20:23], s66 offen  lds
    v_mfma_f32_16x16x32_bf16 v[148:151], a[236:239], v[88:91], v[148:151]
    v_mfma_f32_16x16x32_bf16 v[148:151], a[228:231], v[72:75], v[148:151]
    s_waitcnt lgkmcnt(5)
    v_mfma_f32_16x16x32_bf16 v[156:159], a[228:231], v[76:79], v[156:159]
    s_add_u32 m0, s68, 86016
    s_add_u32 s66, s66, 0x40000
    buffer_load_dwordx4 v1, s[20:23], s66 offen  lds
    s_waitcnt lgkmcnt(4)
    v_mfma_f32_16x16x32_bf16 v[156:159], a[236:239], v[92:95], v[156:159]
    v_mfma_f32_16x16x32_bf16 v[152:155], a[232:235], v[92:95], v[152:155]
    v_mfma_f32_16x16x32_bf16 v[152:155], a[224:227], v[76:79], v[152:155]
    s_add_u32 m0, s68, 90112
    s_add_u32 s66, s66, 0x40000
    buffer_load_dwordx4 v1, s[20:23], s66 offen  lds
    s_waitcnt vmcnt(11) lgkmcnt(0)
    v_mfma_f32_16x16x32_bf16 v[160:163], a[240:243], v[64:67], v[160:163]
    ds_read_b128 a[224:227], v13 offset:32768
    ds_read_b128 a[228:231], v13 offset:34816
    v_mfma_f32_16x16x32_bf16 v[160:163], a[248:251], v[80:83], v[160:163]
    ds_read_b128 a[232:235], v14 offset:32768
    ds_read_b128 a[236:239], v14 offset:34816
    v_mfma_f32_16x16x32_bf16 v[164:167], a[252:255], v[80:83], v[164:167]
    s_add_u32 m0, s68, 98304
    s_add_u32 s66, s75, s83
    buffer_load_dwordx4 v1, s[20:23], s66 offen  lds
    v_mfma_f32_16x16x32_bf16 v[164:167], a[244:247], v[64:67], v[164:167]
    v_mfma_f32_16x16x32_bf16 v[172:175], a[244:247], v[68:71], v[172:175]
    v_mfma_f32_16x16x32_bf16 v[172:175], a[252:255], v[84:87], v[172:175]
    v_mfma_f32_16x16x32_bf16 v[168:171], a[248:251], v[84:87], v[168:171]
    s_add_u32 m0, s68, 102400
    s_add_u32 s66, s66, 0x40000
    buffer_load_dwordx4 v1, s[20:23], s66 offen  lds
    v_mfma_f32_16x16x32_bf16 v[168:171], a[240:243], v[68:71], v[168:171]
    v_mfma_f32_16x16x32_bf16 v[176:179], a[240:243], v[72:75], v[176:179]
    v_mfma_f32_16x16x32_bf16 v[176:179], a[248:251], v[88:91], v[176:179]
    v_mfma_f32_16x16x32_bf16 v[180:183], a[252:255], v[88:91], v[180:183]
    s_add_u32 m0, s68, 106496
    s_add_u32 s66, s66, 0x40000
    buffer_load_dwordx4 v1, s[20:23], s66 offen  lds
    v_mfma_f32_16x16x32_bf16 v[180:183], a[244:247], v[72:75], v[180:183]
    v_mfma_f32_16x16x32_bf16 v[188:191], a[244:247], v[76:79], v[188:191]
    v_mfma_f32_16x16x32_bf16 v[188:191], a[252:255], v[92:95], v[188:191]
    v_mfma_f32_16x16x32_bf16 v[184:187], a[248:251], v[92:95], v[184:187]
    s_add_u32 m0, s68, 110592
    s_add_u32 s66, s66, 0x40000
    buffer_load_dwordx4 v1, s[20:23], s66 offen  lds
    v_mfma_f32_16x16x32_bf16 v[184:187], a[240:243], v[76:79], v[184:187]
    s_waitcnt vmcnt(11) lgkmcnt(0)
    v_mfma_f32_16x16x32_bf16 v[192:195], a[224:227], v[64:67], v[192:195]
    s_add_u32 m0, s68, 114688
    s_add_u32 s66, s66, 0x40000
    buffer_load_dwordx4 v1, s[20:23], s66 offen  lds
    v_mfma_f32_16x16x32_bf16 v[192:195], a[232:235], v[80:83], v[192:195]
    ds_read_b128 a[240:243], v13 offset:49152
    ds_read_b128 a[244:247], v13 offset:51200
    v_mfma_f32_16x16x32_bf16 v[196:199], a[236:239], v[80:83], v[196:199]
    s_add_u32 m0, s68, 118784
    s_add_u32 s66, s66, 0x40000
    buffer_load_dwordx4 v1, s[20:23], s66 offen  lds
    v_mfma_f32_16x16x32_bf16 v[196:199], a[228:231], v[64:67], v[196:199]
    ds_read_b128 a[248:251], v14 offset:49152
    ds_read_b128 a[252:255], v14 offset:51200
    v_mfma_f32_16x16x32_bf16 v[204:207], a[228:231], v[68:71], v[204:207]
    s_add_u32 m0, s68, 122880
    s_add_u32 s66, s66, 0x40000
    buffer_load_dwordx4 v1, s[20:23], s66 offen  lds
    v_mfma_f32_16x16x32_bf16 v[204:207], a[236:239], v[84:87], v[204:207]
    v_mfma_f32_16x16x32_bf16 v[200:203], a[232:235], v[84:87], v[200:203]
    v_mfma_f32_16x16x32_bf16 v[200:203], a[224:227], v[68:71], v[200:203]
    v_mov_b32 v36, 1
    buffer_store_dword v36, v37, s[8:11], 0 offen sc1
    v_mfma_f32_16x16x32_bf16 v[208:211], a[224:227], v[72:75], v[208:211]
    v_mfma_f32_16x16x32_bf16 v[208:211], a[232:235], v[88:91], v[208:211]
    s_add_u32 m0, s67, 0
    s_add_u32 s66, s83, 0
    buffer_load_dwordx4 v2, s[12:15], s66 offen offset:0 nt lds
    v_mfma_f32_16x16x32_bf16 v[212:215], a[236:239], v[88:91], v[212:215]
    v_mfma_f32_16x16x32_bf16 v[212:215], a[228:231], v[72:75], v[212:215]
    buffer_load_dwordx4 v3, s[12:15], s66 offen offset:1024 nt lds
    v_mfma_f32_16x16x32_bf16 v[220:223], a[228:231], v[76:79], v[220:223]
    v_mfma_f32_16x16x32_bf16 v[220:223], a[236:239], v[92:95], v[220:223]
    buffer_load_dwordx4 v2, s[12:15], s66 offen offset:2048 nt lds
    v_mfma_f32_16x16x32_bf16 v[216:219], a[232:235], v[92:95], v[216:219]
    v_mfma_f32_16x16x32_bf16 v[216:219], a[224:227], v[76:79], v[216:219]
    buffer_load_dwordx4 v3, s[12:15], s66 offen offset:3072 nt lds
    s_waitcnt vmcnt(14) lgkmcnt(0)
    s_barrier
    v_mfma_f32_16x16x32_bf16 v[224:227], a[240:243], v[64:67], v[224:227]
    ds_read_b64_tr_b16 a[224:225], v12 offset:0
    ds_read_b64_tr_b16 a[226:227], v12 offset:512
    v_mfma_f32_16x16x32_bf16 v[224:227], a[248:251], v[80:83], v[224:227]
    ds_read_b64_tr_b16 a[228:229], v12 offset:4096
    ds_read_b64_tr_b16 a[230:231], v12 offset:4608
    v_mfma_f32_16x16x32_bf16 v[228:231], a[252:255], v[80:83], v[228:231]
    ds_read_b64_tr_b16 a[232:233], v12 offset:8192
    ds_read_b64_tr_b16 a[234:235], v12 offset:8704
    v_mfma_f32_16x16x32_bf16 v[228:231], a[244:247], v[64:67], v[228:231]
    ds_read_b64_tr_b16 a[236:237], v12 offset:12288
    ds_read_b64_tr_b16 a[238:239], v12 offset:12800
    v_mfma_f32_16x16x32_bf16 v[236:239], a[244:247], v[68:71], v[236:239]
    v_mfma_f32_16x16x32_bf16 v[236:239], a[252:255], v[84:87], v[236:239]
    v_mfma_f32_16x16x32_bf16 v[232:235], a[248:251], v[84:87], v[232:235]
    s_add_u32 m0, s67, 16384
    s_add_u32 s66, s83, 65536
    buffer_load_dwordx4 v2, s[12:15], s66 offen offset:0 nt lds
    v_mfma_f32_16x16x32_bf16 v[232:235], a[240:243], v[68:71], v[232:235]
    v_mfma_f32_16x16x32_bf16 v[240:243], a[240:243], v[72:75], v[240:243]
    v_mfma_f32_16x16x32_bf16 v[240:243], a[248:251], v[88:91], v[240:243]
    buffer_load_dwordx4 v3, s[12:15], s66 offen offset:1024 nt lds
    v_mfma_f32_16x16x32_bf16 v[244:247], a[252:255], v[88:91], v[244:247]
    v_mfma_f32_16x16x32_bf16 v[244:247], a[244:247], v[72:75], v[244:247]
    v_mfma_f32_16x16x32_bf16 v[252:255], a[244:247], v[76:79], v[252:255]
    buffer_load_dwordx4 v2, s[12:15], s66 offen offset:2048 nt lds
    v_mfma_f32_16x16x32_bf16 v[252:255], a[252:255], v[92:95], v[252:255]
    v_mfma_f32_16x16x32_bf16 v[248:251], a[248:251], v[92:95], v[248:251]
    v_mfma_f32_16x16x32_bf16 v[248:251], a[240:243], v[76:79], v[248:251]
    buffer_load_dwordx4 v3, s[12:15], s66 offen offset:3072 nt lds
    s_waitcnt vmcnt(15) lgkmcnt(0)
    s_barrier
    v_mfma_f32_16x16x32_bf16 v[48:51], a[224:227], a[0:3], 0
    ds_read_b64_tr_b16 a[240:241], v12 offset:16384
    ds_read_b64_tr_b16 a[242:243], v12 offset:16896
    v_mfma_f32_16x16x32_bf16 v[48:51], a[228:231], a[16:19], v[48:51]
    ds_read_b64_tr_b16 a[244:245], v12 offset:20480
    ds_read_b64_tr_b16 a[246:247], v12 offset:20992
    v_mfma_f32_16x16x32_bf16 v[48:51], a[232:235], a[32:35], v[48:51]
    ds_read_b64_tr_b16 a[248:249], v12 offset:24576
    ds_read_b64_tr_b16 a[250:251], v12 offset:25088
    v_mfma_f32_16x16x32_bf16 v[48:51], a[236:239], a[48:51], v[48:51]
    v_mfma_f32_16x16x32_bf16 v[52:55], a[236:239], a[52:55], 0
    v_mfma_f32_16x16x32_bf16 v[52:55], a[232:235], a[36:39], v[52:55]
    v_mfma_f32_16x16x32_bf16 v[52:55], a[228:231], a[20:23], v[52:55]
    s_add_u32 m0, s67, 32768
    s_add_u32 s66, s83, 131072
    buffer_load_dwordx4 v2, s[12:15], s66 offen offset:0 nt lds
    v_mfma_f32_16x16x32_bf16 v[52:55], a[224:227], a[4:7], v[52:55]
    v_mfma_f32_16x16x32_bf16 v[56:59], a[224:227], a[8:11], 0
    v_mfma_f32_16x16x32_bf16 v[56:59], a[228:231], a[24:27], v[56:59]
    buffer_load_dwordx4 v3, s[12:15], s66 offen offset:1024 nt lds
    v_mfma_f32_16x16x32_bf16 v[56:59], a[232:235], a[40:43], v[56:59]
    v_mfma_f32_16x16x32_bf16 v[56:59], a[236:239], a[56:59], v[56:59]
    v_mfma_f32_16x16x32_bf16 v[60:63], a[236:239], a[60:63], 0
    buffer_load_dwordx4 v2, s[12:15], s66 offen offset:2048 nt lds
    v_mfma_f32_16x16x32_bf16 v[60:63], a[232:235], a[44:47], v[60:63]
    v_mfma_f32_16x16x32_bf16 v[60:63], a[228:231], a[28:31], v[60:63]
    v_mfma_f32_16x16x32_bf16 v[60:63], a[224:227], a[12:15], v[60:63]
    buffer_load_dwordx4 v3, s[12:15], s66 offen offset:3072 nt lds
    s_waitcnt vmcnt(15) lgkmcnt(0)
    s_barrier
    v_mfma_f32_16x16x32_bf16 v[48:51], a[240:243], a[64:67], v[48:51]
    ds_read_b64_tr_b16 a[224:225], v12 offset:32768
    ds_read_b64_tr_b16 a[226:227], v12 offset:33280
    v_mfma_f32_16x16x32_bf16 v[48:51], a[244:247], a[80:83], v[48:51]
    ds_read_b64_tr_b16 a[228:229], v12 offset:36864
    ds_read_b64_tr_b16 a[230:231], v12 offset:37376
    v_mfma_f32_16x16x32_bf16 v[48:51], a[248:251], a[96:99], v[48:51]
    ds_read_b64_tr_b16 a[232:233], v12 offset:40960
    ds_read_b64_tr_b16 a[234:235], v12 offset:41472
    v_mfma_f32_16x16x32_bf16 v[52:55], a[248:251], a[100:103], v[52:55]
    ds_read_b64_tr_b16 a[236:237], v12 offset:45056
    ds_read_b64_tr_b16 a[238:239], v12 offset:45568
    v_mfma_f32_16x16x32_bf16 v[52:55], a[244:247], a[84:87], v[52:55]
    v_mfma_f32_16x16x32_bf16 v[52:55], a[240:243], a[68:71], v[52:55]
    v_mfma_f32_16x16x32_bf16 v[56:59], a[240:243], a[72:75], v[56:59]
    v_mfma_f32_16x16x32_bf16 v[56:59], a[244:247], a[88:91], v[56:59]
    v_mfma_f32_16x16x32_bf16 v[56:59], a[248:251], a[104:107], v[56:59]
    v_mfma_f32_16x16x32_bf16 v[60:63], a[248:251], a[108:111], v[60:63]
    v_mfma_f32_16x16x32_bf16 v[60:63], a[244:247], a[92:95], v[60:63]
    v_mfma_f32_16x16x32_bf16 v[60:63], a[240:243], a[76:79], v[60:63]
    s_add_u32 m0, s67, 49152
    s_add_u32 s66, s83, 196608
    buffer_load_dwordx4 v2, s[12:15], s66 offen offset:0 nt lds
    buffer_load_dwordx4 v3, s[12:15], s66 offen offset:1024 nt lds
    buffer_load_dwordx4 v2, s[12:15], s66 offen offset:2048 nt lds
    buffer_load_dwordx4 v3, s[12:15], s66 offen offset:3072 nt lds
    s_waitcnt vmcnt(16) lgkmcnt(0)
    s_barrier
    v_mfma_f32_16x16x32_bf16 v[48:51], a[224:227], a[112:115], v[48:51]
    ds_read_b64_tr_b16 a[240:241], v12 offset:49152
    ds_read_b64_tr_b16 a[242:243], v12 offset:49664
    v_mfma_f32_16x16x32_bf16 v[48:51], a[228:231], a[128:131], v[48:51]
    ds_read_b64_tr_b16 a[244:245], v12 offset:53248
    ds_read_b64_tr_b16 a[246:247], v12 offset:53760
    v_mfma_f32_16x16x32_bf16 v[48:51], a[232:235], a[144:147], v[48:51]
    ds_read_b64_tr_b16 a[248:249], v12 offset:57344
    ds_read_b64_tr_b16 a[250:251], v12 offset:57856
    v_mfma_f32_16x16x32_bf16 v[48:51], a[236:239], a[160:163], v[48:51]
    v_mfma_f32_16x16x32_bf16 v[52:55], a[236:239], a[164:167], v[52:55]
    v_mfma_f32_16x16x32_bf16 v[52:55], a[232:235], a[148:151], v[52:55]
    v_mfma_f32_16x16x32_bf16 v[52:55], a[228:231], a[132:135], v[52:55]
    v_mfma_f32_16x16x32_bf16 v[52:55], a[224:227], a[116:119], v[52:55]
    v_mfma_f32_16x16x32_bf16 v[56:59], a[224:227], a[120:123], v[56:59]
    v_mfma_f32_16x16x32_bf16 v[56:59], a[228:231], a[136:139], v[56:59]
    v_mfma_f32_16x16x32_bf16 v[56:59], a[232:235], a[152:155], v[56:59]
    v_mfma_f32_16x16x32_bf16 v[56:59], a[236:239], a[168:171], v[56:59]
    v_mfma_f32_16x16x32_bf16 v[60:63], a[236:239], a[172:175], v[60:63]
    v_mfma_f32_16x16x32_bf16 v[60:63], a[232:235], a[156:159], v[60:63]
    v_mfma_f32_16x16x32_bf16 v[60:63], a[228:231], a[140:143], v[60:63]
    v_mfma_f32_16x16x32_bf16 v[60:63], a[224:227], a[124:127], v[60:63]
    s_waitcnt vmcnt(16) lgkmcnt(0)
    v_mfma_f32_16x16x32_bf16 v[48:51], a[240:243], a[176:179], v[48:51]
    v_mfma_f32_16x16x32_bf16 v[48:51], a[244:247], a[192:195], v[48:51]
    v_mfma_f32_16x16x32_bf16 v[48:51], a[248:251], a[208:211], v[48:51]
    v_mfma_f32_16x16x32_bf16 v[52:55], a[248:251], a[212:215], v[52:55]
    v_mfma_f32_16x16x32_bf16 v[52:55], a[244:247], a[196:199], v[52:55]
    v_mfma_f32_16x16x32_bf16 v[52:55], a[240:243], a[180:183], v[52:55]
    v_mfma_f32_16x16x32_bf16 v[56:59], a[240:243], a[184:187], v[56:59]
    v_mfma_f32_16x16x32_bf16 v[56:59], a[244:247], a[200:203], v[56:59]
    v_mfma_f32_16x16x32_bf16 v[56:59], a[248:251], a[216:219], v[56:59]
    v_mfma_f32_16x16x32_bf16 v[60:63], a[248:251], a[220:223], v[60:63]
    v_mfma_f32_16x16x32_bf16 v[60:63], a[244:247], a[204:207], v[60:63]
    v_mfma_f32_16x16x32_bf16 v[60:63], a[240:243], a[188:191], v[60:63]
    v_cvt_pk_bf16_f32 v40, v48, v49
    v_cvt_pk_bf16_f32 v41, v50, v51
    v_cvt_pk_bf16_f32 v42, v52, v53
    v_cvt_pk_bf16_f32 v43, v54, v55
    s_nop 0
    v_cvt_pk_bf16_f32 v44, v56, v57
    v_cvt_pk_bf16_f32 v45, v58, v59
    s_nop 0
    v_cvt_pk_bf16_f32 v46, v60, v61
    v_cvt_pk_bf16_f32 v47, v62, v63
    ds_write_b64 v27, v[40:41] offset:0
    ds_write_b64 v27, v[42:43] offset:1024
    ds_write_b64 v27, v[44:45] offset:2048
    ds_write_b64 v27, v[46:47] offset:3072
    s_waitcnt vmcnt(12)
    ds_read_b128 a[224:227], v13 offset:0
    ds_read_b128 a[228:231], v13 offset:2048
    ds_read_b128 a[232:235], v14 offset:0
    ds_read_b128 a[236:239], v14 offset:2048
    s_waitcnt vmcnt(12) lgkmcnt(0)
    s_barrier
    ds_read_b128 v[64:67], v29 offset:0
    ds_read_b128 v[80:83], v29 offset:4096
    ds_read_b128 v[68:71], v29 offset:1024
    ds_read_b128 v[84:87], v29 offset:5120
    ds_read_b128 v[72:75], v29 offset:2048
    ds_read_b128 v[88:91], v29 offset:6144
    ds_read_b128 v[76:79], v29 offset:3072
    ds_read_b128 v[92:95], v29 offset:7168
    s_waitcnt lgkmcnt(7)
    v_mfma_f32_16x16x32_bf16 v[128:131], a[224:227], v[64:67], v[128:131]
    s_waitcnt lgkmcnt(6)
    v_mfma_f32_16x16x32_bf16 v[128:131], a[232:235], v[80:83], v[128:131]
    v_mfma_f32_16x16x32_bf16 v[132:135], a[236:239], v[80:83], v[132:135]
    v_mfma_f32_16x16x32_bf16 v[132:135], a[228:231], v[64:67], v[132:135]
    s_waitcnt lgkmcnt(5)
    v_mfma_f32_16x16x32_bf16 v[140:143], a[228:231], v[68:71], v[140:143]
    s_waitcnt lgkmcnt(4)
    v_mfma_f32_16x16x32_bf16 v[140:143], a[236:239], v[84:87], v[140:143]
    v_mfma_f32_16x16x32_bf16 v[136:139], a[232:235], v[84:87], v[136:139]
    v_mfma_f32_16x16x32_bf16 v[136:139], a[224:227], v[68:71], v[136:139]
    s_waitcnt lgkmcnt(3)
    v_mfma_f32_16x16x32_bf16 v[144:147], a[224:227], v[72:75], v[144:147]
    s_waitcnt lgkmcnt(2)
    v_mfma_f32_16x16x32_bf16 v[144:147], a[232:235], v[88:91], v[144:147]
    s_waitcnt vmcnt(8) lgkmcnt(0)
    v_mfma_f32_16x16x32_bf16 v[148:151], a[236:239], v[88:91], v[148:151]
    ds_read_b128 a[240:243], v13 offset:16384
    ds_read_b128 a[244:247], v13 offset:18432
    v_mfma_f32_16x16x32_bf16 v[148:151], a[228:231], v[72:75], v[148:151]
    ds_read_b128 a[248:251], v14 offset:16384
    ds_read_b128 a[252:255], v14 offset:18432
    v_mfma_f32_16x16x32_bf16 v[156:159], a[228:231], v[76:79], v[156:159]
    s_add_u32 m0, s67, 65536
    s_add_u32 s66, s80, 0
    buffer_load_dwordx4 v4, s[16:19], s66 offen offset:0 nt lds
    v_mfma_f32_16x16x32_bf16 v[156:159], a[236:239], v[92:95], v[156:159]
    buffer_load_dwordx4 v4, s[16:19], s66 offen offset:1024 nt lds
    v_mfma_f32_16x16x32_bf16 v[152:155], a[232:235], v[92:95], v[152:155]
    buffer_load_dwordx4 v4, s[16:19], s66 offen offset:2048 nt lds
    v_mfma_f32_16x16x32_bf16 v[152:155], a[224:227], v[76:79], v[152:155]
    buffer_load_dwordx4 v4, s[16:19], s66 offen offset:3072 nt lds
    s_lshl_b32 s6, s58, 2
    v_lshl_add_u32 v1, v0, 4, s6
    v_and_b32 v2, 15, v0
    v_lshlrev_b32 v2, 4, v2
    v_add_u32 v3, 147456, v2
    s_lshl_b32 s6, s62, 12
    v_add_u32 v29, s6, v29
    v_xor_b32 v30, 0x1000, v29
    s_waitcnt vmcnt(12) lgkmcnt(0)
    v_mfma_f32_16x16x32_bf16 v[160:163], a[240:243], v[64:67], v[160:163]
    v_max3_f32 v112, v128, v129, v130
    v_max3_f32 v113, v136, v137, v138
    v_max3_f32 v114, v144, v145, v146
    v_mfma_f32_16x16x32_bf16 v[160:163], a[248:251], v[80:83], v[160:163]
    v_max3_f32 v115, v152, v153, v154
    v_max3_f32 v112, v131, v132, v112
    v_max3_f32 v113, v139, v140, v113
    v_mfma_f32_16x16x32_bf16 v[164:167], a[252:255], v[80:83], v[164:167]
    v_max3_f32 v114, v147, v148, v114
    v_max3_f32 v115, v155, v156, v115
    v_max3_f32 v112, v133, v134, v112
    v_mfma_f32_16x16x32_bf16 v[164:167], a[244:247], v[64:67], v[164:167]
    v_max3_f32 v113, v141, v142, v113
    v_max3_f32 v114, v149, v150, v114
    v_max3_f32 v115, v157, v158, v115
    v_mfma_f32_16x16x32_bf16 v[172:175], a[244:247], v[68:71], v[172:175]
    v_max_f32 v112, v135, v112
    v_max_f32 v113, v143, v113
    v_mfma_f32_16x16x32_bf16 v[172:175], a[252:255], v[84:87], v[172:175]
    v_max_f32 v114, v151, v114
    v_max_f32 v115, v159, v115
    v_mfma_f32_16x16x32_bf16 v[168:171], a[248:251], v[84:87], v[168:171]
    v_mul_f32 v112, s70, v112
    v_mul_f32 v113, s70, v113
    v_mfma_f32_16x16x32_bf16 v[168:171], a[240:243], v[68:71], v[168:171]
    v_mul_f32 v114, s70, v114
    v_mul_f32 v115, s70, v115
    v_mfma_f32_16x16x32_bf16 v[176:179], a[240:243], v[72:75], v[176:179]
    v_pk_fma_f32 v[128:129], v[128:129], s[70:71], v[112:113] op_sel:[0,0,0] op_sel_hi:[1,1,0] neg_lo:[0,0,1] neg_hi:[0,0,1]
    v_pk_fma_f32 v[130:131], v[130:131], s[70:71], v[112:113] op_sel:[0,0,0] op_sel_hi:[1,1,0] neg_lo:[0,0,1] neg_hi:[0,0,1]
    v_exp_f32 v128, v128
    v_exp_f32 v129, v129
    v_exp_f32 v130, v130
    v_exp_f32 v131, v131
    v_mfma_f32_16x16x32_bf16 v[176:179], a[248:251], v[88:91], v[176:179]
    v_pk_fma_f32 v[132:133], v[132:133], s[70:71], v[112:113] op_sel:[0,0,0] op_sel_hi:[1,1,0] neg_lo:[0,0,1] neg_hi:[0,0,1]
    v_pk_fma_f32 v[134:135], v[134:135], s[70:71], v[112:113] op_sel:[0,0,0] op_sel_hi:[1,1,0] neg_lo:[0,0,1] neg_hi:[0,0,1]
    v_exp_f32 v132, v132
    v_exp_f32 v133, v133
    v_exp_f32 v134, v134
    v_exp_f32 v135, v135
    v_mfma_f32_16x16x32_bf16 v[180:183], a[252:255], v[88:91], v[180:183]
    v_pk_fma_f32 v[136:137], v[136:137], s[70:71], v[112:113] op_sel:[0,0,1] op_sel_hi:[1,1,1] neg_lo:[0,0,1] neg_hi:[0,0,1]
    v_pk_fma_f32 v[138:139], v[138:139], s[70:71], v[112:113] op_sel:[0,0,1] op_sel_hi:[1,1,1] neg_lo:[0,0,1] neg_hi:[0,0,1]
    v_exp_f32 v136, v136
    v_exp_f32 v137, v137
    v_exp_f32 v138, v138
    v_exp_f32 v139, v139
    v_mfma_f32_16x16x32_bf16 v[180:183], a[244:247], v[72:75], v[180:183]
    v_pk_fma_f32 v[140:141], v[140:141], s[70:71], v[112:113] op_sel:[0,0,1] op_sel_hi:[1,1,1] neg_lo:[0,0,1] neg_hi:[0,0,1]
    v_pk_fma_f32 v[142:143], v[142:143], s[70:71], v[112:113] op_sel:[0,0,1] op_sel_hi:[1,1,1] neg_lo:[0,0,1] neg_hi:[0,0,1]
    v_exp_f32 v140, v140
    v_exp_f32 v141, v141
    v_exp_f32 v142, v142
    v_exp_f32 v143, v143
    v_mfma_f32_16x16x32_bf16 v[188:191], a[244:247], v[76:79], v[188:191]
    v_pk_fma_f32 v[144:145], v[144:145], s[70:71], v[114:115] op_sel:[0,0,0] op_sel_hi:[1,1,0] neg_lo:[0,0,1] neg_hi:[0,0,1]
    v_pk_fma_f32 v[146:147], v[146:147], s[70:71], v[114:115] op_sel:[0,0,0] op_sel_hi:[1,1,0] neg_lo:[0,0,1] neg_hi:[0,0,1]
    v_exp_f32 v144, v144
    v_exp_f32 v145, v145
    v_exp_f32 v146, v146
    v_exp_f32 v147, v147
    v_mfma_f32_16x16x32_bf16 v[188:191], a[252:255], v[92:95], v[188:191]
    v_pk_fma_f32 v[148:149], v[148:149], s[70:71], v[114:115] op_sel:[0,0,0] op_sel_hi:[1,1,0] neg_lo:[0,0,1] neg_hi:[0,0,1]
    v_pk_fma_f32 v[150:151], v[150:151], s[70:71], v[114:115] op_sel:[0,0,0] op_sel_hi:[1,1,0] neg_lo:[0,0,1] neg_hi:[0,0,1]
    v_exp_f32 v148, v148
    v_exp_f32 v149, v149
    v_exp_f32 v150, v150
    v_exp_f32 v151, v151
    v_mfma_f32_16x16x32_bf16 v[184:187], a[248:251], v[92:95], v[184:187]
    v_pk_fma_f32 v[152:153], v[152:153], s[70:71], v[114:115] op_sel:[0,0,1] op_sel_hi:[1,1,1] neg_lo:[0,0,1] neg_hi:[0,0,1]
    v_pk_fma_f32 v[154:155], v[154:155], s[70:71], v[114:115] op_sel:[0,0,1] op_sel_hi:[1,1,1] neg_lo:[0,0,1] neg_hi:[0,0,1]
    v_exp_f32 v152, v152
    v_exp_f32 v153, v153
    v_exp_f32 v154, v154
    v_exp_f32 v155, v155
    v_mfma_f32_16x16x32_bf16 v[184:187], a[240:243], v[76:79], v[184:187]
    v_pk_fma_f32 v[156:157], v[156:157], s[70:71], v[114:115] op_sel:[0,0,1] op_sel_hi:[1,1,1] neg_lo:[0,0,1] neg_hi:[0,0,1]
    v_pk_fma_f32 v[158:159], v[158:159], s[70:71], v[114:115] op_sel:[0,0,1] op_sel_hi:[1,1,1] neg_lo:[0,0,1] neg_hi:[0,0,1]
    v_exp_f32 v156, v156
    v_exp_f32 v157, v157
    v_exp_f32 v158, v158
    v_exp_f32 v159, v159
    s_waitcnt vmcnt(8)
    ds_read_b128 a[224:227], v13 offset:32768
    ds_read_b128 a[228:231], v13 offset:34816
    ds_read_b128 a[232:235], v14 offset:32768
    ds_read_b128 a[236:239], v14 offset:34816
    v_pk_add_f32 v[56:57], v[128:129], v[130:131]
    v_pk_add_f32 v[58:59], v[136:137], v[138:139]
    v_pk_add_f32 v[60:61], v[144:145], v[146:147]
    v_pk_add_f32 v[62:63], v[152:153], v[154:155]
    v_pk_add_f32 v[56:57], v[56:57], v[132:133]
    v_pk_add_f32 v[58:59], v[58:59], v[140:141]
    v_pk_add_f32 v[60:61], v[60:61], v[148:149]
    v_pk_add_f32 v[62:63], v[62:63], v[156:157]
    v_pk_add_f32 v[56:57], v[56:57], v[134:135]
    v_pk_add_f32 v[58:59], v[58:59], v[142:143]
    v_pk_add_f32 v[60:61], v[60:61], v[150:151]
    v_pk_add_f32 v[62:63], v[62:63], v[158:159]
    v_add_f32 v48, v56, v57
    v_add_f32 v49, v58, v59
    v_add_f32 v50, v60, v61
    v_add_f32 v51, v62, v63
    s_add_u32 m0, s67, 81920
    s_add_u32 s66, s80, 65536
    buffer_load_dwordx4 v4, s[16:19], s66 offen offset:0 nt lds
    buffer_load_dwordx4 v4, s[16:19], s66 offen offset:1024 nt lds
    buffer_load_dwordx4 v4, s[16:19], s66 offen offset:2048 nt lds
    buffer_load_dwordx4 v4, s[16:19], s66 offen offset:3072 nt lds
    s_waitcnt vmcnt(12) lgkmcnt(0)
    v_mfma_f32_16x16x32_bf16 v[192:195], a[224:227], v[64:67], v[192:195]
    v_max3_f32 v116, v160, v161, v162
    v_max3_f32 v117, v168, v169, v170
    v_max3_f32 v118, v176, v177, v178
    v_mfma_f32_16x16x32_bf16 v[192:195], a[232:235], v[80:83], v[192:195]
    v_max3_f32 v119, v184, v185, v186
    v_max3_f32 v116, v163, v164, v116
    v_max3_f32 v117, v171, v172, v117
    v_mfma_f32_16x16x32_bf16 v[196:199], a[236:239], v[80:83], v[196:199]
    v_max3_f32 v118, v179, v180, v118
    v_max3_f32 v119, v187, v188, v119
    v_max3_f32 v116, v165, v166, v116
    v_mfma_f32_16x16x32_bf16 v[196:199], a[228:231], v[64:67], v[196:199]
    v_max3_f32 v117, v173, v174, v117
    v_max3_f32 v118, v181, v182, v118
    v_max3_f32 v119, v189, v190, v119
    v_mfma_f32_16x16x32_bf16 v[204:207], a[228:231], v[68:71], v[204:207]
    v_max_f32 v116, v167, v116
    v_max_f32 v117, v175, v117
    v_mfma_f32_16x16x32_bf16 v[204:207], a[236:239], v[84:87], v[204:207]
    v_max_f32 v118, v183, v118
    v_max_f32 v119, v191, v119
    v_mfma_f32_16x16x32_bf16 v[200:203], a[232:235], v[84:87], v[200:203]
    v_mul_f32 v116, s70, v116
    v_mul_f32 v117, s70, v117
    v_mfma_f32_16x16x32_bf16 v[200:203], a[224:227], v[68:71], v[200:203]
    v_mul_f32 v118, s70, v118
    v_mul_f32 v119, s70, v119
    v_mfma_f32_16x16x32_bf16 v[208:211], a[224:227], v[72:75], v[208:211]
    v_pk_fma_f32 v[160:161], v[160:161], s[70:71], v[116:117] op_sel:[0,0,0] op_sel_hi:[1,1,0] neg_lo:[0,0,1] neg_hi:[0,0,1]
    v_pk_fma_f32 v[162:163], v[162:163], s[70:71], v[116:117] op_sel:[0,0,0] op_sel_hi:[1,1,0] neg_lo:[0,0,1] neg_hi:[0,0,1]
    v_exp_f32 v160, v160
    v_exp_f32 v161, v161
    v_exp_f32 v162, v162
    v_exp_f32 v163, v163
    v_mfma_f32_16x16x32_bf16 v[208:211], a[232:235], v[88:91], v[208:211]
    v_pk_fma_f32 v[164:165], v[164:165], s[70:71], v[116:117] op_sel:[0,0,0] op_sel_hi:[1,1,0] neg_lo:[0,0,1] neg_hi:[0,0,1]
    v_pk_fma_f32 v[166:167], v[166:167], s[70:71], v[116:117] op_sel:[0,0,0] op_sel_hi:[1,1,0] neg_lo:[0,0,1] neg_hi:[0,0,1]
    v_exp_f32 v164, v164
    v_exp_f32 v165, v165
    v_exp_f32 v166, v166
    v_exp_f32 v167, v167
    v_mfma_f32_16x16x32_bf16 v[212:215], a[236:239], v[88:91], v[212:215]
    v_pk_fma_f32 v[168:169], v[168:169], s[70:71], v[116:117] op_sel:[0,0,1] op_sel_hi:[1,1,1] neg_lo:[0,0,1] neg_hi:[0,0,1]
    v_pk_fma_f32 v[170:171], v[170:171], s[70:71], v[116:117] op_sel:[0,0,1] op_sel_hi:[1,1,1] neg_lo:[0,0,1] neg_hi:[0,0,1]
    v_exp_f32 v168, v168
    v_exp_f32 v169, v169
    v_exp_f32 v170, v170
    v_exp_f32 v171, v171
    v_mfma_f32_16x16x32_bf16 v[212:215], a[228:231], v[72:75], v[212:215]
    v_pk_fma_f32 v[172:173], v[172:173], s[70:71], v[116:117] op_sel:[0,0,1] op_sel_hi:[1,1,1] neg_lo:[0,0,1] neg_hi:[0,0,1]
    v_pk_fma_f32 v[174:175], v[174:175], s[70:71], v[116:117] op_sel:[0,0,1] op_sel_hi:[1,1,1] neg_lo:[0,0,1] neg_hi:[0,0,1]
    v_exp_f32 v172, v172
    v_exp_f32 v173, v173
    v_exp_f32 v174, v174
    v_exp_f32 v175, v175
    v_mfma_f32_16x16x32_bf16 v[220:223], a[228:231], v[76:79], v[220:223]
    v_pk_fma_f32 v[176:177], v[176:177], s[70:71], v[118:119] op_sel:[0,0,0] op_sel_hi:[1,1,0] neg_lo:[0,0,1] neg_hi:[0,0,1]
    v_pk_fma_f32 v[178:179], v[178:179], s[70:71], v[118:119] op_sel:[0,0,0] op_sel_hi:[1,1,0] neg_lo:[0,0,1] neg_hi:[0,0,1]
    v_exp_f32 v176, v176
    v_exp_f32 v177, v177
    v_exp_f32 v178, v178
    v_exp_f32 v179, v179
    v_mfma_f32_16x16x32_bf16 v[220:223], a[236:239], v[92:95], v[220:223]
    v_pk_fma_f32 v[180:181], v[180:181], s[70:71], v[118:119] op_sel:[0,0,0] op_sel_hi:[1,1,0] neg_lo:[0,0,1] neg_hi:[0,0,1]
    v_pk_fma_f32 v[182:183], v[182:183], s[70:71], v[118:119] op_sel:[0,0,0] op_sel_hi:[1,1,0] neg_lo:[0,0,1] neg_hi:[0,0,1]
    v_exp_f32 v180, v180
    v_exp_f32 v181, v181
    v_exp_f32 v182, v182
    v_exp_f32 v183, v183
    v_mfma_f32_16x16x32_bf16 v[216:219], a[232:235], v[92:95], v[216:219]
    v_pk_fma_f32 v[184:185], v[184:185], s[70:71], v[118:119] op_sel:[0,0,1] op_sel_hi:[1,1,1] neg_lo:[0,0,1] neg_hi:[0,0,1]
    v_pk_fma_f32 v[186:187], v[186:187], s[70:71], v[118:119] op_sel:[0,0,1] op_sel_hi:[1,1,1] neg_lo:[0,0,1] neg_hi:[0,0,1]
    v_exp_f32 v184, v184
    v_exp_f32 v185, v185
    v_exp_f32 v186, v186
    v_exp_f32 v187, v187
    v_mfma_f32_16x16x32_bf16 v[216:219], a[224:227], v[76:79], v[216:219]
    v_pk_fma_f32 v[188:189], v[188:189], s[70:71], v[118:119] op_sel:[0,0,1] op_sel_hi:[1,1,1] neg_lo:[0,0,1] neg_hi:[0,0,1]
    v_pk_fma_f32 v[190:191], v[190:191], s[70:71], v[118:119] op_sel:[0,0,1] op_sel_hi:[1,1,1] neg_lo:[0,0,1] neg_hi:[0,0,1]
    v_exp_f32 v188, v188
    v_exp_f32 v189, v189
    v_exp_f32 v190, v190
    v_exp_f32 v191, v191
    s_waitcnt vmcnt(8)
    ds_read_b128 a[240:243], v13 offset:49152
    ds_read_b128 a[244:247], v13 offset:51200
    ds_read_b128 a[248:251], v14 offset:49152
    ds_read_b128 a[252:255], v14 offset:51200
    v_pk_add_f32 v[56:57], v[160:161], v[162:163]
    v_pk_add_f32 v[58:59], v[168:169], v[170:171]
    v_pk_add_f32 v[60:61], v[176:177], v[178:179]
    v_pk_add_f32 v[62:63], v[184:185], v[186:187]
    v_pk_add_f32 v[56:57], v[56:57], v[164:165]
    v_pk_add_f32 v[58:59], v[58:59], v[172:173]
    v_pk_add_f32 v[60:61], v[60:61], v[180:181]
    v_pk_add_f32 v[62:63], v[62:63], v[188:189]
    v_pk_add_f32 v[56:57], v[56:57], v[166:167]
    v_pk_add_f32 v[58:59], v[58:59], v[174:175]
    v_pk_add_f32 v[60:61], v[60:61], v[182:183]
    v_pk_add_f32 v[62:63], v[62:63], v[190:191]
    v_add_f32 v52, v56, v57
    v_add_f32 v53, v58, v59
    v_add_f32 v54, v60, v61
    v_add_f32 v55, v62, v63
    s_add_u32 m0, s67, 98304
    s_add_u32 s66, s80, 131072
    buffer_load_dwordx4 v4, s[16:19], s66 offen offset:0 nt lds
    buffer_load_dwordx4 v4, s[16:19], s66 offen offset:1024 nt lds
    buffer_load_dwordx4 v4, s[16:19], s66 offen offset:2048 nt lds
    buffer_load_dwordx4 v4, s[16:19], s66 offen offset:3072 nt lds
    s_waitcnt lgkmcnt(0)
    v_mfma_f32_16x16x32_bf16 v[224:227], a[240:243], v[64:67], v[224:227]
    v_max3_f32 v120, v192, v193, v194
    v_max3_f32 v121, v200, v201, v202
    v_max3_f32 v122, v208, v209, v210
    v_mfma_f32_16x16x32_bf16 v[224:227], a[248:251], v[80:83], v[224:227]
    v_max3_f32 v123, v216, v217, v218
    v_max3_f32 v120, v195, v196, v120
    v_max3_f32 v121, v203, v204, v121
    v_mfma_f32_16x16x32_bf16 v[228:231], a[252:255], v[80:83], v[228:231]
    v_max3_f32 v122, v211, v212, v122
    v_max3_f32 v123, v219, v220, v123
    v_max3_f32 v120, v197, v198, v120
    v_mfma_f32_16x16x32_bf16 v[228:231], a[244:247], v[64:67], v[228:231]
    v_max3_f32 v121, v205, v206, v121
    v_max3_f32 v122, v213, v214, v122
    v_max3_f32 v123, v221, v222, v123
    v_mfma_f32_16x16x32_bf16 v[236:239], a[244:247], v[68:71], v[236:239]
    v_max_f32 v120, v199, v120
    v_max_f32 v121, v207, v121
    v_mfma_f32_16x16x32_bf16 v[236:239], a[252:255], v[84:87], v[236:239]
    v_max_f32 v122, v215, v122
    v_max_f32 v123, v223, v123
    v_mfma_f32_16x16x32_bf16 v[232:235], a[248:251], v[84:87], v[232:235]
    v_mul_f32 v120, s70, v120
    v_mul_f32 v121, s70, v121
    v_mfma_f32_16x16x32_bf16 v[232:235], a[240:243], v[68:71], v[232:235]
    v_mul_f32 v122, s70, v122
    v_mul_f32 v123, s70, v123
    v_mfma_f32_16x16x32_bf16 v[240:243], a[240:243], v[72:75], v[240:243]
    v_pk_fma_f32 v[192:193], v[192:193], s[70:71], v[120:121] op_sel:[0,0,0] op_sel_hi:[1,1,0] neg_lo:[0,0,1] neg_hi:[0,0,1]
    v_pk_fma_f32 v[194:195], v[194:195], s[70:71], v[120:121] op_sel:[0,0,0] op_sel_hi:[1,1,0] neg_lo:[0,0,1] neg_hi:[0,0,1]
    v_exp_f32 v192, v192
    v_exp_f32 v193, v193
    v_exp_f32 v194, v194
    v_exp_f32 v195, v195
    v_mfma_f32_16x16x32_bf16 v[240:243], a[248:251], v[88:91], v[240:243]
    v_pk_fma_f32 v[196:197], v[196:197], s[70:71], v[120:121] op_sel:[0,0,0] op_sel_hi:[1,1,0] neg_lo:[0,0,1] neg_hi:[0,0,1]
    v_pk_fma_f32 v[198:199], v[198:199], s[70:71], v[120:121] op_sel:[0,0,0] op_sel_hi:[1,1,0] neg_lo:[0,0,1] neg_hi:[0,0,1]
    v_exp_f32 v196, v196
    v_exp_f32 v197, v197
    v_exp_f32 v198, v198
    v_exp_f32 v199, v199
    v_mfma_f32_16x16x32_bf16 v[244:247], a[252:255], v[88:91], v[244:247]
    v_pk_fma_f32 v[200:201], v[200:201], s[70:71], v[120:121] op_sel:[0,0,1] op_sel_hi:[1,1,1] neg_lo:[0,0,1] neg_hi:[0,0,1]
    v_pk_fma_f32 v[202:203], v[202:203], s[70:71], v[120:121] op_sel:[0,0,1] op_sel_hi:[1,1,1] neg_lo:[0,0,1] neg_hi:[0,0,1]
    v_exp_f32 v200, v200
    v_exp_f32 v201, v201
    v_exp_f32 v202, v202
    v_exp_f32 v203, v203
    v_mfma_f32_16x16x32_bf16 v[244:247], a[244:247], v[72:75], v[244:247]
    v_pk_fma_f32 v[204:205], v[204:205], s[70:71], v[120:121] op_sel:[0,0,1] op_sel_hi:[1,1,1] neg_lo:[0,0,1] neg_hi:[0,0,1]
    v_pk_fma_f32 v[206:207], v[206:207], s[70:71], v[120:121] op_sel:[0,0,1] op_sel_hi:[1,1,1] neg_lo:[0,0,1] neg_hi:[0,0,1]
    v_exp_f32 v204, v204
    v_exp_f32 v205, v205
    v_exp_f32 v206, v206
    v_exp_f32 v207, v207
    v_mfma_f32_16x16x32_bf16 v[252:255], a[244:247], v[76:79], v[252:255]
    v_pk_fma_f32 v[208:209], v[208:209], s[70:71], v[122:123] op_sel:[0,0,0] op_sel_hi:[1,1,0] neg_lo:[0,0,1] neg_hi:[0,0,1]
    v_pk_fma_f32 v[210:211], v[210:211], s[70:71], v[122:123] op_sel:[0,0,0] op_sel_hi:[1,1,0] neg_lo:[0,0,1] neg_hi:[0,0,1]
    v_exp_f32 v208, v208
    v_exp_f32 v209, v209
    v_exp_f32 v210, v210
    v_exp_f32 v211, v211
    v_mfma_f32_16x16x32_bf16 v[252:255], a[252:255], v[92:95], v[252:255]
    v_pk_fma_f32 v[212:213], v[212:213], s[70:71], v[122:123] op_sel:[0,0,0] op_sel_hi:[1,1,0] neg_lo:[0,0,1] neg_hi:[0,0,1]
    v_pk_fma_f32 v[214:215], v[214:215], s[70:71], v[122:123] op_sel:[0,0,0] op_sel_hi:[1,1,0] neg_lo:[0,0,1] neg_hi:[0,0,1]
    v_exp_f32 v212, v212
    v_exp_f32 v213, v213
    v_exp_f32 v214, v214
    v_exp_f32 v215, v215
    v_mfma_f32_16x16x32_bf16 v[248:251], a[248:251], v[92:95], v[248:251]
    v_pk_fma_f32 v[216:217], v[216:217], s[70:71], v[122:123] op_sel:[0,0,1] op_sel_hi:[1,1,1] neg_lo:[0,0,1] neg_hi:[0,0,1]
    v_pk_fma_f32 v[218:219], v[218:219], s[70:71], v[122:123] op_sel:[0,0,1] op_sel_hi:[1,1,1] neg_lo:[0,0,1] neg_hi:[0,0,1]
    v_exp_f32 v216, v216
    v_exp_f32 v217, v217
    v_exp_f32 v218, v218
    v_exp_f32 v219, v219
    v_mfma_f32_16x16x32_bf16 v[248:251], a[240:243], v[76:79], v[248:251]
    v_pk_fma_f32 v[220:221], v[220:221], s[70:71], v[122:123] op_sel:[0,0,1] op_sel_hi:[1,1,1] neg_lo:[0,0,1] neg_hi:[0,0,1]
    v_pk_fma_f32 v[222:223], v[222:223], s[70:71], v[122:123] op_sel:[0,0,1] op_sel_hi:[1,1,1] neg_lo:[0,0,1] neg_hi:[0,0,1]
    v_exp_f32 v220, v220
    v_exp_f32 v221, v221
    v_exp_f32 v222, v222
    v_exp_f32 v223, v223
    v_max3_f32 v124, v224, v225, v226
    v_max3_f32 v125, v232, v233, v234
    v_max3_f32 v126, v240, v241, v242
    v_max3_f32 v127, v248, v249, v250
    v_max3_f32 v124, v227, v228, v124
    v_max3_f32 v125, v235, v236, v125
    v_max3_f32 v126, v243, v244, v126
    v_max3_f32 v127, v251, v252, v127
    v_max3_f32 v124, v229, v230, v124
    v_max3_f32 v125, v237, v238, v125
    v_max3_f32 v126, v245, v246, v126
    v_max3_f32 v127, v253, v254, v127
    v_max_f32 v124, v231, v124
    v_max_f32 v125, v239, v125
    v_max_f32 v126, v247, v126
    v_max_f32 v127, v255, v127
    v_mul_f32 v124, s70, v124
    v_mul_f32 v125, s70, v125
    v_mul_f32 v126, s70, v126
    v_mul_f32 v127, s70, v127
    v_max3_f32 v124, v124, v112, v116
    v_max3_f32 v125, v125, v113, v117
    v_max3_f32 v126, v126, v114, v118
    v_max3_f32 v127, v127, v115, v119
    v_max_f32 v124, v124, v120
    v_max_f32 v125, v125, v121
    v_max_f32 v126, v126, v122
    v_max_f32 v127, v127, v123
    s_nop 0
    v_permlane32_swap_b32 v124, v126
    v_permlane32_swap_b32 v125, v127
    v_max_f32 v124, v124, v126
    v_max_f32 v125, v125, v127
    s_nop 1
    v_permlane16_swap_b32 v124, v125
    v_max_f32 v124, v124, v125
    v_add_u32 v56, 147456, v1
    ds_write_b32 v56, v124
    s_add_u32 m0, s67, 114688
    s_add_u32 s66, s80, 196608
    buffer_load_dwordx4 v4, s[16:19], s66 offen offset:0 nt lds
    buffer_load_dwordx4 v4, s[16:19], s66 offen offset:1024 nt lds
    buffer_load_dwordx4 v4, s[16:19], s66 offen offset:2048 nt lds
    buffer_load_dwordx4 v4, s[16:19], s66 offen offset:3072 nt lds
    s_waitcnt vmcnt(12) lgkmcnt(0)
    s_barrier
    ds_read_b128 v[96:99], v3 offset:0
    ds_read_b128 v[100:103], v3 offset:256
    ds_read_b128 v[104:107], v3 offset:512
    ds_read_b128 v[108:111], v3 offset:768
    ds_read_b64_tr_b16 a[224:225], v15 offset:0
    ds_read_b64_tr_b16 a[226:227], v15 offset:2048
    ds_read_b64_tr_b16 a[228:229], v16 offset:0
    ds_read_b64_tr_b16 a[230:231], v16 offset:2048
    ds_read_b64_tr_b16 a[232:233], v17 offset:0
    ds_read_b64_tr_b16 a[234:235], v17 offset:2048
    ds_read_b64_tr_b16 a[236:237], v18 offset:0
    ds_read_b64_tr_b16 a[238:239], v18 offset:2048
    s_waitcnt lgkmcnt(8)
    v_max3_f32 v96, v96, v97, v98
    v_max3_f32 v100, v100, v101, v102
    v_max3_f32 v104, v104, v105, v106
    v_max3_f32 v108, v108, v109, v110
    v_max_f32 v124, v96, v99
    v_max_f32 v125, v100, v103
    v_max_f32 v126, v104, v107
    v_max_f32 v127, v108, v111
    v_sub_f32 v112, v112, v124
    v_sub_f32 v113, v113, v125
    v_sub_f32 v114, v114, v126
    v_sub_f32 v115, v115, v127
    v_sub_f32 v116, v116, v124
    v_sub_f32 v117, v117, v125
    v_sub_f32 v118, v118, v126
    v_sub_f32 v119, v119, v127
    v_sub_f32 v120, v120, v124
    v_sub_f32 v121, v121, v125
    v_sub_f32 v122, v122, v126
    v_sub_f32 v123, v123, v127
    v_exp_f32 v112, v112
    v_exp_f32 v113, v113
    v_exp_f32 v114, v114
    v_exp_f32 v115, v115
    v_exp_f32 v116, v116
    v_exp_f32 v117, v117
    v_exp_f32 v118, v118
    v_exp_f32 v119, v119
    v_exp_f32 v120, v120
    v_exp_f32 v121, v121
    v_exp_f32 v122, v122
    v_exp_f32 v123, v123
    v_mul_f32 v40, v48, v112
    v_mul_f32 v41, v52, v116
    v_mul_f32 v42, v49, v113
    v_mul_f32 v43, v53, v117
    v_mul_f32 v44, v50, v114
    v_mul_f32 v45, v54, v118
    v_mul_f32 v46, v51, v115
    v_mul_f32 v47, v55, v119
    v_pk_mul_f32 v[128:129], v[128:129], v[112:113] op_sel:[0,0] op_sel_hi:[1,0]
    v_pk_mul_f32 v[130:131], v[130:131], v[112:113] op_sel:[0,0] op_sel_hi:[1,0]
    v_pk_mul_f32 v[132:133], v[132:133], v[112:113] op_sel:[0,0] op_sel_hi:[1,0]
    v_pk_mul_f32 v[134:135], v[134:135], v[112:113] op_sel:[0,0] op_sel_hi:[1,0]
    v_cvt_pk_bf16_f32 v64, v128, v129
    v_cvt_pk_bf16_f32 v65, v130, v131
    v_cvt_pk_bf16_f32 v66, v132, v133
    v_cvt_pk_bf16_f32 v67, v134, v135
    v_pk_mul_f32 v[136:137], v[136:137], v[112:113] op_sel:[0,1] op_sel_hi:[1,1]
    v_pk_mul_f32 v[138:139], v[138:139], v[112:113] op_sel:[0,1] op_sel_hi:[1,1]
    v_pk_mul_f32 v[140:141], v[140:141], v[112:113] op_sel:[0,1] op_sel_hi:[1,1]
    v_pk_mul_f32 v[142:143], v[142:143], v[112:113] op_sel:[0,1] op_sel_hi:[1,1]
    v_cvt_pk_bf16_f32 v68, v136, v137
    v_cvt_pk_bf16_f32 v69, v138, v139
    v_cvt_pk_bf16_f32 v70, v140, v141
    v_cvt_pk_bf16_f32 v71, v142, v143
    v_pk_mul_f32 v[144:145], v[144:145], v[114:115] op_sel:[0,0] op_sel_hi:[1,0]
    v_pk_mul_f32 v[146:147], v[146:147], v[114:115] op_sel:[0,0] op_sel_hi:[1,0]
    v_pk_mul_f32 v[148:149], v[148:149], v[114:115] op_sel:[0,0] op_sel_hi:[1,0]
    v_pk_mul_f32 v[150:151], v[150:151], v[114:115] op_sel:[0,0] op_sel_hi:[1,0]
    v_cvt_pk_bf16_f32 v72, v144, v145
    v_cvt_pk_bf16_f32 v73, v146, v147
    v_cvt_pk_bf16_f32 v74, v148, v149
    v_cvt_pk_bf16_f32 v75, v150, v151
    v_pk_mul_f32 v[152:153], v[152:153], v[114:115] op_sel:[0,1] op_sel_hi:[1,1]
    v_pk_mul_f32 v[154:155], v[154:155], v[114:115] op_sel:[0,1] op_sel_hi:[1,1]
    v_pk_mul_f32 v[156:157], v[156:157], v[114:115] op_sel:[0,1] op_sel_hi:[1,1]
    v_pk_mul_f32 v[158:159], v[158:159], v[114:115] op_sel:[0,1] op_sel_hi:[1,1]
    v_cvt_pk_bf16_f32 v76, v152, v153
    v_cvt_pk_bf16_f32 v77, v154, v155
    v_cvt_pk_bf16_f32 v78, v156, v157
    v_cvt_pk_bf16_f32 v79, v158, v159
    ds_write_b128 v23, v[64:67] offset:0
    v_pk_fma_f32 v[224:225], v[224:225], s[70:71], v[124:125] op_sel:[0,0,0] op_sel_hi:[1,1,0] neg_lo:[0,0,1] neg_hi:[0,0,1]
    v_pk_fma_f32 v[226:227], v[226:227], s[70:71], v[124:125] op_sel:[0,0,0] op_sel_hi:[1,1,0] neg_lo:[0,0,1] neg_hi:[0,0,1]
    v_exp_f32 v224, v224
    v_exp_f32 v225, v225
    v_exp_f32 v226, v226
    v_exp_f32 v227, v227
    ds_write_b128 v23, v[68:71] offset:1024
    v_pk_fma_f32 v[228:229], v[228:229], s[70:71], v[124:125] op_sel:[0,0,0] op_sel_hi:[1,1,0] neg_lo:[0,0,1] neg_hi:[0,0,1]
    v_pk_fma_f32 v[230:231], v[230:231], s[70:71], v[124:125] op_sel:[0,0,0] op_sel_hi:[1,1,0] neg_lo:[0,0,1] neg_hi:[0,0,1]
    v_exp_f32 v228, v228
    v_exp_f32 v229, v229
    v_exp_f32 v230, v230
    v_exp_f32 v231, v231
    ds_write_b128 v23, v[72:75] offset:2048
    v_pk_fma_f32 v[232:233], v[232:233], s[70:71], v[124:125] op_sel:[0,0,1] op_sel_hi:[1,1,1] neg_lo:[0,0,1] neg_hi:[0,0,1]
    v_pk_fma_f32 v[234:235], v[234:235], s[70:71], v[124:125] op_sel:[0,0,1] op_sel_hi:[1,1,1] neg_lo:[0,0,1] neg_hi:[0,0,1]
    v_exp_f32 v232, v232
    v_exp_f32 v233, v233
    v_exp_f32 v234, v234
    v_exp_f32 v235, v235
    ds_write_b128 v23, v[76:79] offset:3072
    v_pk_fma_f32 v[236:237], v[236:237], s[70:71], v[124:125] op_sel:[0,0,1] op_sel_hi:[1,1,1] neg_lo:[0,0,1] neg_hi:[0,0,1]
    v_pk_fma_f32 v[238:239], v[238:239], s[70:71], v[124:125] op_sel:[0,0,1] op_sel_hi:[1,1,1] neg_lo:[0,0,1] neg_hi:[0,0,1]
    v_exp_f32 v236, v236
    v_exp_f32 v237, v237
    v_exp_f32 v238, v238
    v_exp_f32 v239, v239
    s_add_u32 m0, s68, 0
    s_add_u32 s66, s76, s84
    buffer_load_dwordx4 v5, s[24:27], s66 offen  lds
    s_add_u32 m0, s68, 4096
    s_nop 0
    buffer_load_dwordx4 v6, s[24:27], s66 offen  lds
    s_add_u32 m0, s68, 8192
    s_nop 0
    buffer_load_dwordx4 v7, s[24:27], s66 offen  lds
    s_add_u32 m0, s68, 12288
    s_nop 0
    buffer_load_dwordx4 v8, s[24:27], s66 offen  lds
    s_waitcnt vmcnt(12) lgkmcnt(0)
    s_barrier
    ds_read_b128 a[0:3], v24 offset:0
    ds_read_b128 a[16:19], v25 offset:0
    ds_read_b128 a[32:35], v26 offset:0
    v_pk_fma_f32 v[240:241], v[240:241], s[70:71], v[126:127] op_sel:[0,0,0] op_sel_hi:[1,1,0] neg_lo:[0,0,1] neg_hi:[0,0,1]
    v_pk_fma_f32 v[242:243], v[242:243], s[70:71], v[126:127] op_sel:[0,0,0] op_sel_hi:[1,1,0] neg_lo:[0,0,1] neg_hi:[0,0,1]
    v_exp_f32 v240, v240
    v_exp_f32 v241, v241
    v_exp_f32 v242, v242
    v_exp_f32 v243, v243
    v_pk_fma_f32 v[244:245], v[244:245], s[70:71], v[126:127] op_sel:[0,0,0] op_sel_hi:[1,1,0] neg_lo:[0,0,1] neg_hi:[0,0,1]
    v_pk_fma_f32 v[246:247], v[246:247], s[70:71], v[126:127] op_sel:[0,0,0] op_sel_hi:[1,1,0] neg_lo:[0,0,1] neg_hi:[0,0,1]
    v_exp_f32 v244, v244
    v_exp_f32 v245, v245
    v_exp_f32 v246, v246
    ds_read_b128 a[4:7], v24 offset:1024
    ds_read_b128 a[20:23], v25 offset:1024
    ds_read_b128 a[36:39], v26 offset:1024
    v_exp_f32 v247, v247
    v_pk_fma_f32 v[248:249], v[248:249], s[70:71], v[126:127] op_sel:[0,0,1] op_sel_hi:[1,1,1] neg_lo:[0,0,1] neg_hi:[0,0,1]
    v_pk_fma_f32 v[250:251], v[250:251], s[70:71], v[126:127] op_sel:[0,0,1] op_sel_hi:[1,1,1] neg_lo:[0,0,1] neg_hi:[0,0,1]
    v_exp_f32 v248, v248
    v_exp_f32 v249, v249
    v_exp_f32 v250, v250
    v_exp_f32 v251, v251
    v_pk_fma_f32 v[252:253], v[252:253], s[70:71], v[126:127] op_sel:[0,0,1] op_sel_hi:[1,1,1] neg_lo:[0,0,1] neg_hi:[0,0,1]
    v_pk_fma_f32 v[254:255], v[254:255], s[70:71], v[126:127] op_sel:[0,0,1] op_sel_hi:[1,1,1] neg_lo:[0,0,1] neg_hi:[0,0,1]
    v_exp_f32 v252, v252
    v_exp_f32 v253, v253
    ds_read_b128 a[8:11], v24 offset:2048
    ds_read_b128 a[24:27], v25 offset:2048
    ds_read_b128 a[40:43], v26 offset:2048
    v_exp_f32 v254, v254
    v_exp_f32 v255, v255
    v_pk_mul_f32 v[160:161], v[160:161], v[116:117] op_sel:[0,0] op_sel_hi:[1,0]
    v_pk_mul_f32 v[162:163], v[162:163], v[116:117] op_sel:[0,0] op_sel_hi:[1,0]
    v_pk_mul_f32 v[164:165], v[164:165], v[116:117] op_sel:[0,0] op_sel_hi:[1,0]
    v_pk_mul_f32 v[166:167], v[166:167], v[116:117] op_sel:[0,0] op_sel_hi:[1,0]
    v_cvt_pk_bf16_f32 v80, v160, v161
    v_cvt_pk_bf16_f32 v81, v162, v163
    v_cvt_pk_bf16_f32 v82, v164, v165
    v_cvt_pk_bf16_f32 v83, v166, v167
    v_pk_mul_f32 v[168:169], v[168:169], v[116:117] op_sel:[0,1] op_sel_hi:[1,1]
    ds_read_b128 a[12:15], v24 offset:3072
    ds_read_b128 a[28:31], v25 offset:3072
    ds_read_b128 a[44:47], v26 offset:3072
    v_pk_mul_f32 v[170:171], v[170:171], v[116:117] op_sel:[0,1] op_sel_hi:[1,1]
    v_pk_mul_f32 v[172:173], v[172:173], v[116:117] op_sel:[0,1] op_sel_hi:[1,1]
    v_pk_mul_f32 v[174:175], v[174:175], v[116:117] op_sel:[0,1] op_sel_hi:[1,1]
    v_cvt_pk_bf16_f32 v84, v168, v169
    v_cvt_pk_bf16_f32 v85, v170, v171
    v_cvt_pk_bf16_f32 v86, v172, v173
    v_cvt_pk_bf16_f32 v87, v174, v175
    v_pk_mul_f32 v[176:177], v[176:177], v[118:119] op_sel:[0,0] op_sel_hi:[1,0]
    v_pk_mul_f32 v[178:179], v[178:179], v[118:119] op_sel:[0,0] op_sel_hi:[1,0]
    v_pk_mul_f32 v[180:181], v[180:181], v[118:119] op_sel:[0,0] op_sel_hi:[1,0]
    v_pk_mul_f32 v[182:183], v[182:183], v[118:119] op_sel:[0,0] op_sel_hi:[1,0]
    v_cvt_pk_bf16_f32 v88, v176, v177
    v_cvt_pk_bf16_f32 v89, v178, v179
    v_cvt_pk_bf16_f32 v90, v180, v181
    v_cvt_pk_bf16_f32 v91, v182, v183
    v_pk_mul_f32 v[184:185], v[184:185], v[118:119] op_sel:[0,1] op_sel_hi:[1,1]
    v_pk_mul_f32 v[186:187], v[186:187], v[118:119] op_sel:[0,1] op_sel_hi:[1,1]
    v_pk_mul_f32 v[188:189], v[188:189], v[118:119] op_sel:[0,1] op_sel_hi:[1,1]
    v_pk_mul_f32 v[190:191], v[190:191], v[118:119] op_sel:[0,1] op_sel_hi:[1,1]
    v_cvt_pk_bf16_f32 v92, v184, v185
    v_cvt_pk_bf16_f32 v93, v186, v187
    v_cvt_pk_bf16_f32 v94, v188, v189
    v_cvt_pk_bf16_f32 v95, v190, v191
    s_waitcnt lgkmcnt(0)
    v_mfma_f32_16x16x32_bf16 v[48:51], a[224:227], v[64:67], 0
    ds_write_b128 v23, v[80:83] offset:16384
    v_mfma_f32_16x16x32_bf16 v[48:51], a[228:231], a[0:3], v[48:51]
    v_mfma_f32_16x16x32_bf16 v[48:51], a[232:235], a[16:19], v[48:51]
    s_add_u32 m0, s68, 16384
    s_nop 0
    buffer_load_dwordx4 v9, s[24:27], s66 offen  lds
    v_mfma_f32_16x16x32_bf16 v[48:51], a[236:239], a[32:35], v[48:51]
    ds_read_b64_tr_b16 a[240:241], v15 offset:16384
    ds_read_b64_tr_b16 a[242:243], v15 offset:18432
    v_mfma_f32_16x16x32_bf16 v[52:55], a[236:239], a[36:39], 0
    ds_write_b128 v23, v[84:87] offset:17408
    v_mfma_f32_16x16x32_bf16 v[52:55], a[232:235], a[20:23], v[52:55]
    v_mfma_f32_16x16x32_bf16 v[52:55], a[228:231], a[4:7], v[52:55]
    s_add_u32 m0, s68, 20480
    s_nop 0
    buffer_load_dwordx4 v10, s[24:27], s66 offen  lds
    v_mfma_f32_16x16x32_bf16 v[52:55], a[224:227], v[68:71], v[52:55]
    ds_read_b64_tr_b16 a[244:245], v16 offset:16384
    ds_read_b64_tr_b16 a[246:247], v16 offset:18432
    v_mfma_f32_16x16x32_bf16 v[56:59], a[224:227], v[72:75], 0
    ds_write_b128 v23, v[88:91] offset:18432
    v_mfma_f32_16x16x32_bf16 v[56:59], a[228:231], a[8:11], v[56:59]
    s_add_u32 m0, s68, 24576
    s_nop 0
    buffer_load_dwordx4 v11, s[24:27], s66 offen  lds
    v_mfma_f32_16x16x32_bf16 v[56:59], a[232:235], a[24:27], v[56:59]
    ds_read_b64_tr_b16 a[252:253], v18 offset:16384
    ds_read_b64_tr_b16 a[254:255], v18 offset:18432
    v_mfma_f32_16x16x32_bf16 v[56:59], a[236:239], a[40:43], v[56:59]
    ds_read_b64_tr_b16 a[248:249], v17 offset:16384
    ds_read_b64_tr_b16 a[250:251], v17 offset:18432
    v_mfma_f32_16x16x32_bf16 v[60:63], a[236:239], a[44:47], 0
    ds_write_b128 v23, v[92:95] offset:19456
    v_mfma_f32_16x16x32_bf16 v[60:63], a[232:235], a[28:31], v[60:63]
    v_mfma_f32_16x16x32_bf16 v[60:63], a[228:231], a[12:15], v[60:63]
    v_mfma_f32_16x16x32_bf16 v[60:63], a[224:227], v[76:79], v[60:63]
    s_waitcnt vmcnt(11) lgkmcnt(0)
    s_barrier
    ds_read_b128 a[48:51], v24 offset:16384
    ds_read_b128 a[64:67], v25 offset:16384
    ds_read_b128 a[80:83], v26 offset:16384
    v_pk_mul_f32 v[192:193], v[192:193], v[120:121] op_sel:[0,0] op_sel_hi:[1,0]
    v_pk_mul_f32 v[194:195], v[194:195], v[120:121] op_sel:[0,0] op_sel_hi:[1,0]
    v_pk_mul_f32 v[196:197], v[196:197], v[120:121] op_sel:[0,0] op_sel_hi:[1,0]
    v_pk_mul_f32 v[198:199], v[198:199], v[120:121] op_sel:[0,0] op_sel_hi:[1,0]
    v_pk_add_f32 v[40:41], v[40:41], v[192:193]
    v_cvt_pk_bf16_f32 v96, v192, v193
    v_pk_add_f32 v[40:41], v[40:41], v[194:195]
    v_cvt_pk_bf16_f32 v97, v194, v195
    v_pk_add_f32 v[40:41], v[40:41], v[196:197]
    ds_read_b128 a[52:55], v24 offset:17408
    ds_read_b128 a[68:71], v25 offset:17408
    ds_read_b128 a[84:87], v26 offset:17408
    v_cvt_pk_bf16_f32 v98, v196, v197
    v_pk_add_f32 v[40:41], v[40:41], v[198:199]
    v_cvt_pk_bf16_f32 v99, v198, v199
    v_pk_mul_f32 v[200:201], v[200:201], v[120:121] op_sel:[0,1] op_sel_hi:[1,1]
    v_pk_mul_f32 v[202:203], v[202:203], v[120:121] op_sel:[0,1] op_sel_hi:[1,1]
    v_pk_mul_f32 v[204:205], v[204:205], v[120:121] op_sel:[0,1] op_sel_hi:[1,1]
    v_pk_mul_f32 v[206:207], v[206:207], v[120:121] op_sel:[0,1] op_sel_hi:[1,1]
    v_pk_add_f32 v[42:43], v[42:43], v[200:201]
    v_cvt_pk_bf16_f32 v100, v200, v201
    ds_read_b128 a[56:59], v24 offset:18432
    ds_read_b128 a[72:75], v25 offset:18432
    ds_read_b128 a[88:91], v26 offset:18432
    v_pk_add_f32 v[42:43], v[42:43], v[202:203]
    v_cvt_pk_bf16_f32 v101, v202, v203
    v_pk_add_f32 v[42:43], v[42:43], v[204:205]
    v_cvt_pk_bf16_f32 v102, v204, v205
    v_pk_add_f32 v[42:43], v[42:43], v[206:207]
    v_cvt_pk_bf16_f32 v103, v206, v207
    v_pk_mul_f32 v[208:209], v[208:209], v[122:123] op_sel:[0,0] op_sel_hi:[1,0]
    v_pk_mul_f32 v[210:211], v[210:211], v[122:123] op_sel:[0,0] op_sel_hi:[1,0]
    v_pk_mul_f32 v[212:213], v[212:213], v[122:123] op_sel:[0,0] op_sel_hi:[1,0]
    ds_read_b128 a[60:63], v24 offset:19456
    ds_read_b128 a[76:79], v25 offset:19456
    ds_read_b128 a[92:95], v26 offset:19456
    v_pk_mul_f32 v[214:215], v[214:215], v[122:123] op_sel:[0,0] op_sel_hi:[1,0]
    v_pk_add_f32 v[44:45], v[44:45], v[208:209]
    v_cvt_pk_bf16_f32 v104, v208, v209
    v_pk_add_f32 v[44:45], v[44:45], v[210:211]
    v_cvt_pk_bf16_f32 v105, v210, v211
    v_pk_add_f32 v[44:45], v[44:45], v[212:213]
    v_cvt_pk_bf16_f32 v106, v212, v213
    v_pk_add_f32 v[44:45], v[44:45], v[214:215]
    v_cvt_pk_bf16_f32 v107, v214, v215
    v_pk_mul_f32 v[216:217], v[216:217], v[122:123] op_sel:[0,1] op_sel_hi:[1,1]
    v_pk_mul_f32 v[218:219], v[218:219], v[122:123] op_sel:[0,1] op_sel_hi:[1,1]
    v_pk_mul_f32 v[220:221], v[220:221], v[122:123] op_sel:[0,1] op_sel_hi:[1,1]
    v_pk_mul_f32 v[222:223], v[222:223], v[122:123] op_sel:[0,1] op_sel_hi:[1,1]
    v_pk_add_f32 v[46:47], v[46:47], v[216:217]
    v_cvt_pk_bf16_f32 v108, v216, v217
    v_pk_add_f32 v[46:47], v[46:47], v[218:219]
    v_cvt_pk_bf16_f32 v109, v218, v219
    v_pk_add_f32 v[46:47], v[46:47], v[220:221]
    v_cvt_pk_bf16_f32 v110, v220, v221
    v_pk_add_f32 v[46:47], v[46:47], v[222:223]
    v_cvt_pk_bf16_f32 v111, v222, v223
    s_waitcnt lgkmcnt(0)
    v_mfma_f32_16x16x32_bf16 v[48:51], a[240:243], v[80:83], v[48:51]
    ds_write_b128 v23, v[96:99] offset:0
    v_mfma_f32_16x16x32_bf16 v[48:51], a[244:247], a[48:51], v[48:51]
    v_mfma_f32_16x16x32_bf16 v[48:51], a[248:251], a[64:67], v[48:51]
    s_add_u32 m0, s68, 32768
    s_add_u32 s66, s77, s84
    buffer_load_dwordx4 v5, s[24:27], s66 offen  lds
    v_mfma_f32_16x16x32_bf16 v[48:51], a[252:255], a[80:83], v[48:51]
    ds_read_b64_tr_b16 a[224:225], v15 offset:32768
    ds_read_b64_tr_b16 a[226:227], v15 offset:34816
    v_mfma_f32_16x16x32_bf16 v[52:55], a[252:255], a[84:87], v[52:55]
    ds_write_b128 v23, v[100:103] offset:1024
    v_mfma_f32_16x16x32_bf16 v[52:55], a[248:251], a[68:71], v[52:55]
    v_mfma_f32_16x16x32_bf16 v[52:55], a[244:247], a[52:55], v[52:55]
    s_add_u32 m0, s68, 36864
    s_nop 0
    buffer_load_dwordx4 v6, s[24:27], s66 offen  lds
    v_mfma_f32_16x16x32_bf16 v[52:55], a[240:243], v[84:87], v[52:55]
    ds_read_b64_tr_b16 a[228:229], v16 offset:32768
    ds_read_b64_tr_b16 a[230:231], v16 offset:34816
    v_mfma_f32_16x16x32_bf16 v[56:59], a[240:243], v[88:91], v[56:59]
    ds_write_b128 v23, v[104:107] offset:2048
    v_mfma_f32_16x16x32_bf16 v[56:59], a[244:247], a[56:59], v[56:59]
    s_add_u32 m0, s68, 40960
    s_nop 0
    buffer_load_dwordx4 v7, s[24:27], s66 offen  lds
    v_mfma_f32_16x16x32_bf16 v[56:59], a[248:251], a[72:75], v[56:59]
    ds_read_b64_tr_b16 a[236:237], v18 offset:32768
    ds_read_b64_tr_b16 a[238:239], v18 offset:34816
    v_mfma_f32_16x16x32_bf16 v[56:59], a[252:255], a[88:91], v[56:59]
    ds_read_b64_tr_b16 a[232:233], v17 offset:32768
    ds_read_b64_tr_b16 a[234:235], v17 offset:34816
    v_mfma_f32_16x16x32_bf16 v[60:63], a[252:255], a[92:95], v[60:63]
    ds_write_b128 v23, v[108:111] offset:3072
    v_mfma_f32_16x16x32_bf16 v[60:63], a[248:251], a[76:79], v[60:63]
    v_mfma_f32_16x16x32_bf16 v[60:63], a[244:247], a[60:63], v[60:63]
    s_add_u32 m0, s68, 45056
    s_nop 0
    buffer_load_dwordx4 v8, s[24:27], s66 offen  lds
    v_mfma_f32_16x16x32_bf16 v[60:63], a[240:243], v[92:95], v[60:63]
    s_add_u32 m0, s68, 49152
    s_nop 0
    buffer_load_dwordx4 v9, s[24:27], s66 offen  lds
    s_add_u32 m0, s68, 53248
    s_nop 0
    buffer_load_dwordx4 v10, s[24:27], s66 offen  lds
    s_add_u32 m0, s68, 57344
    s_nop 0
    buffer_load_dwordx4 v11, s[24:27], s66 offen  lds
    s_add_u32 m0, s67, 65536
    s_add_u32 s66, s81, 0
    buffer_load_dwordx4 v4, s[16:19], s66 offen offset:0 nt lds
    buffer_load_dwordx4 v4, s[16:19], s66 offen offset:1024 nt lds
    buffer_load_dwordx4 v4, s[16:19], s66 offen offset:2048 nt lds
    buffer_load_dwordx4 v4, s[16:19], s66 offen offset:3072 nt lds
    s_waitcnt vmcnt(18) lgkmcnt(0)
    s_barrier
    ds_read_b128 a[96:99], v24 offset:0
    ds_read_b128 a[112:115], v25 offset:0
    ds_read_b128 a[128:131], v26 offset:0
    v_pk_add_f32 v[40:41], v[40:41], v[224:225]
    v_cvt_pk_bf16_f32 v112, v224, v225
    v_pk_add_f32 v[40:41], v[40:41], v[226:227]
    v_cvt_pk_bf16_f32 v113, v226, v227
    v_pk_add_f32 v[40:41], v[40:41], v[228:229]
    v_cvt_pk_bf16_f32 v114, v228, v229
    ds_read_b128 a[100:103], v24 offset:1024
    ds_read_b128 a[116:119], v25 offset:1024
    ds_read_b128 a[132:135], v26 offset:1024
    v_pk_add_f32 v[40:41], v[40:41], v[230:231]
    v_cvt_pk_bf16_f32 v115, v230, v231
    v_pk_add_f32 v[42:43], v[42:43], v[232:233]
    v_cvt_pk_bf16_f32 v116, v232, v233
    v_pk_add_f32 v[42:43], v[42:43], v[234:235]
    v_cvt_pk_bf16_f32 v117, v234, v235
    ds_read_b128 a[104:107], v24 offset:2048
    ds_read_b128 a[120:123], v25 offset:2048
    ds_read_b128 a[136:139], v26 offset:2048
    v_pk_add_f32 v[42:43], v[42:43], v[236:237]
    v_cvt_pk_bf16_f32 v118, v236, v237
    v_pk_add_f32 v[42:43], v[42:43], v[238:239]
    v_cvt_pk_bf16_f32 v119, v238, v239
    v_pk_add_f32 v[44:45], v[44:45], v[240:241]
    v_cvt_pk_bf16_f32 v120, v240, v241
    ds_read_b128 a[108:111], v24 offset:3072
    ds_read_b128 a[124:127], v25 offset:3072
    ds_read_b128 a[140:143], v26 offset:3072
    v_pk_add_f32 v[44:45], v[44:45], v[242:243]
    v_cvt_pk_bf16_f32 v121, v242, v243
    v_pk_add_f32 v[44:45], v[44:45], v[244:245]
    v_cvt_pk_bf16_f32 v122, v244, v245
    v_pk_add_f32 v[44:45], v[44:45], v[246:247]
    v_cvt_pk_bf16_f32 v123, v246, v247
    v_pk_add_f32 v[46:47], v[46:47], v[248:249]
    v_cvt_pk_bf16_f32 v124, v248, v249
    v_pk_add_f32 v[46:47], v[46:47], v[250:251]
    v_cvt_pk_bf16_f32 v125, v250, v251
    v_pk_add_f32 v[46:47], v[46:47], v[252:253]
    v_cvt_pk_bf16_f32 v126, v252, v253
    v_pk_add_f32 v[46:47], v[46:47], v[254:255]
    v_cvt_pk_bf16_f32 v127, v254, v255
    v_add_f32 v32, v40, v41
    v_add_f32 v33, v42, v43
    v_add_f32 v34, v44, v45
    v_add_f32 v35, v46, v47
    s_nop 0
    v_permlane32_swap_b32 v32, v34
    v_permlane32_swap_b32 v33, v35
    v_add_f32 v32, v32, v34
    v_add_f32 v33, v33, v35
    s_nop 1
    v_permlane16_swap_b32 v32, v33
    v_add_f32 v32, v32, v33
    s_waitcnt lgkmcnt(0)
    v_mfma_f32_16x16x32_bf16 v[48:51], a[224:227], v[96:99], v[48:51]
    ds_write_b32 v1, v32 offset:28672
    ds_write_b128 v23, v[112:115] offset:16384
    v_mfma_f32_16x16x32_bf16 v[48:51], a[228:231], a[96:99], v[48:51]
    v_mfma_f32_16x16x32_bf16 v[48:51], a[232:235], a[112:115], v[48:51]
    s_add_u32 m0, s67, 81920
    s_add_u32 s66, s81, 65536
    buffer_load_dwordx4 v4, s[16:19], s66 offen offset:0 nt lds
    v_mfma_f32_16x16x32_bf16 v[48:51], a[236:239], a[128:131], v[48:51]
    ds_read_b64_tr_b16 a[240:241], v15 offset:49152
    ds_read_b64_tr_b16 a[242:243], v15 offset:51200
    v_mfma_f32_16x16x32_bf16 v[52:55], a[236:239], a[132:135], v[52:55]
    ds_write_b128 v23, v[116:119] offset:17408
    v_mfma_f32_16x16x32_bf16 v[52:55], a[232:235], a[116:119], v[52:55]
    v_mfma_f32_16x16x32_bf16 v[52:55], a[228:231], a[100:103], v[52:55]
    buffer_load_dwordx4 v4, s[16:19], s66 offen offset:1024 nt lds
    v_mfma_f32_16x16x32_bf16 v[52:55], a[224:227], v[100:103], v[52:55]
    ds_read_b64_tr_b16 a[244:245], v16 offset:49152
    ds_read_b64_tr_b16 a[246:247], v16 offset:51200
    v_mfma_f32_16x16x32_bf16 v[56:59], a[224:227], v[104:107], v[56:59]
    ds_write_b128 v23, v[120:123] offset:18432
    v_mfma_f32_16x16x32_bf16 v[56:59], a[228:231], a[104:107], v[56:59]
    buffer_load_dwordx4 v4, s[16:19], s66 offen offset:2048 nt lds
    v_mfma_f32_16x16x32_bf16 v[56:59], a[232:235], a[120:123], v[56:59]
    ds_read_b64_tr_b16 a[252:253], v18 offset:49152
    ds_read_b64_tr_b16 a[254:255], v18 offset:51200
    v_mfma_f32_16x16x32_bf16 v[56:59], a[236:239], a[136:139], v[56:59]
    ds_read_b64_tr_b16 a[248:249], v17 offset:49152
    ds_read_b64_tr_b16 a[250:251], v17 offset:51200
    v_mfma_f32_16x16x32_bf16 v[60:63], a[236:239], a[140:143], v[60:63]
    ds_write_b128 v23, v[124:127] offset:19456
    v_mfma_f32_16x16x32_bf16 v[60:63], a[232:235], a[124:127], v[60:63]
    v_mfma_f32_16x16x32_bf16 v[60:63], a[228:231], a[108:111], v[60:63]
    buffer_load_dwordx4 v4, s[16:19], s66 offen offset:3072 nt lds
    v_mfma_f32_16x16x32_bf16 v[60:63], a[224:227], v[108:111], v[60:63]
    s_waitcnt vmcnt(22) lgkmcnt(0)
    s_barrier
    ds_read_b128 a[144:147], v24 offset:16384
    ds_read_b128 a[160:163], v25 offset:16384
    ds_read_b128 a[176:179], v26 offset:16384
    ds_read_b128 a[148:151], v24 offset:17408
    ds_read_b128 a[164:167], v25 offset:17408
    ds_read_b128 a[180:183], v26 offset:17408
    ds_read_b128 a[152:155], v24 offset:18432
    ds_read_b128 a[168:171], v25 offset:18432
    ds_read_b128 a[184:187], v26 offset:18432
    ds_read_b128 a[156:159], v24 offset:19456
    ds_read_b128 a[172:175], v25 offset:19456
    ds_read_b128 a[188:191], v26 offset:19456
    v_mfma_f32_16x16x32_bf16 v[48:51], a[240:243], v[112:115], v[48:51]
    ds_read_b128 v[240:243], v2 offset:28672
    s_waitcnt lgkmcnt(12)
    v_mfma_f32_16x16x32_bf16 v[48:51], a[244:247], a[144:147], v[48:51]
    ds_read_b128 v[244:247], v2 offset:28928
    s_waitcnt lgkmcnt(12)
    v_mfma_f32_16x16x32_bf16 v[48:51], a[248:251], a[160:163], v[48:51]
    ds_read_b128 v[248:251], v2 offset:29184
    s_waitcnt lgkmcnt(12)
    v_mfma_f32_16x16x32_bf16 v[48:51], a[252:255], a[176:179], v[48:51]
    ds_read_b128 v[252:255], v2 offset:29440
    s_waitcnt lgkmcnt(10)
    v_mfma_f32_16x16x32_bf16 v[52:55], a[252:255], a[180:183], v[52:55]
    v_mfma_f32_16x16x32_bf16 v[52:55], a[248:251], a[164:167], v[52:55]
    v_mfma_f32_16x16x32_bf16 v[52:55], a[244:247], a[148:151], v[52:55]
    v_mfma_f32_16x16x32_bf16 v[52:55], a[240:243], v[116:119], v[52:55]
    v_mfma_f32_16x16x32_bf16 v[56:59], a[240:243], v[120:123], v[56:59]
    s_waitcnt lgkmcnt(9)
    v_mfma_f32_16x16x32_bf16 v[56:59], a[244:247], a[152:155], v[56:59]
    s_waitcnt lgkmcnt(8)
    v_mfma_f32_16x16x32_bf16 v[56:59], a[248:251], a[168:171], v[56:59]
    s_waitcnt lgkmcnt(3)
    v_add_f32 v240, v240, v241
    v_add_f32 v242, v242, v243
    s_waitcnt lgkmcnt(2)
    v_add_f32 v244, v244, v245
    v_add_f32 v246, v246, v247
    v_mfma_f32_16x16x32_bf16 v[56:59], a[252:255], a[184:187], v[56:59]
    s_waitcnt lgkmcnt(1)
    v_add_f32 v248, v248, v249
    v_add_f32 v250, v250, v251
    s_waitcnt lgkmcnt(0)
    v_add_f32 v252, v252, v253
    v_add_f32 v254, v254, v255
    v_mfma_f32_16x16x32_bf16 v[60:63], a[252:255], a[188:191], v[60:63]
    v_add_f32 v240, v240, v242
    v_rcp_f32 v32, v240
    v_mfma_f32_16x16x32_bf16 v[60:63], a[248:251], a[172:175], v[60:63]
    v_add_f32 v244, v244, v246
    v_rcp_f32 v33, v244
    v_mfma_f32_16x16x32_bf16 v[60:63], a[244:247], a[156:159], v[60:63]
    v_add_f32 v248, v248, v250
    v_rcp_f32 v34, v248
    v_mfma_f32_16x16x32_bf16 v[60:63], a[240:243], v[124:127], v[60:63]
    v_add_f32 v252, v252, v254
    v_rcp_f32 v35, v252
    s_add_u32 m0, s67, 98304
    s_add_u32 s66, s81, 131072
    buffer_load_dwordx4 v4, s[16:19], s66 offen offset:0 nt lds
    buffer_load_dwordx4 v4, s[16:19], s66 offen offset:1024 nt lds
    buffer_load_dwordx4 v4, s[16:19], s66 offen offset:2048 nt lds
    buffer_load_dwordx4 v4, s[16:19], s66 offen offset:3072 nt lds
    v_pk_mul_f32 v[48:49], v[48:49], v[32:33] op_sel:[0,0] op_sel_hi:[1,0]
    v_pk_mul_f32 v[50:51], v[50:51], v[32:33] op_sel:[0,0] op_sel_hi:[1,0]
    v_cvt_pk_bf16_f32 v40, v48, v49
    v_cvt_pk_bf16_f32 v41, v50, v51
    v_pk_mul_f32 v[52:53], v[52:53], v[32:33] op_sel:[0,1] op_sel_hi:[1,1]
    v_pk_mul_f32 v[54:55], v[54:55], v[32:33] op_sel:[0,1] op_sel_hi:[1,1]
    v_cvt_pk_bf16_f32 v42, v52, v53
    v_cvt_pk_bf16_f32 v43, v54, v55
    v_pk_mul_f32 v[56:57], v[56:57], v[34:35] op_sel:[0,0] op_sel_hi:[1,0]
    v_pk_mul_f32 v[58:59], v[58:59], v[34:35] op_sel:[0,0] op_sel_hi:[1,0]
    v_cvt_pk_bf16_f32 v44, v56, v57
    v_cvt_pk_bf16_f32 v45, v58, v59
    v_pk_mul_f32 v[60:61], v[60:61], v[34:35] op_sel:[0,1] op_sel_hi:[1,1]
    v_pk_mul_f32 v[62:63], v[62:63], v[34:35] op_sel:[0,1] op_sel_hi:[1,1]
    v_cvt_pk_bf16_f32 v46, v60, v61
    v_cvt_pk_bf16_f32 v47, v62, v63
    ds_write_b64 v28, v[40:41] offset:0
    ds_write_b64 v28, v[42:43] offset:1024
    ds_write_b64 v28, v[44:45] offset:2048
    ds_write_b64 v28, v[46:47] offset:3072
    s_waitcnt vmcnt(12) lgkmcnt(0)
    s_barrier
    ds_read_b64_tr_b16 a[224:225], v19 offset:0
    ds_read_b64_tr_b16 a[226:227], v19 offset:14336
    ds_read_b64_tr_b16 a[228:229], v19 offset:32768
    ds_read_b64_tr_b16 a[230:231], v19 offset:47104
    ds_read_b128 a[192:195], v29 offset:0
    ds_read_b128 a[208:211], v30 offset:0
    ds_read_b128 a[196:199], v29 offset:1024
    ds_read_b128 a[212:215], v30 offset:1024
    ds_read_b128 a[200:203], v29 offset:2048
    ds_read_b128 a[216:219], v30 offset:2048
    ds_read_b128 a[204:207], v29 offset:3072
    ds_read_b128 a[220:223], v30 offset:3072
    ds_read_b64_tr_b16 a[232:233], v20 offset:0
    ds_read_b64_tr_b16 a[234:235], v20 offset:14336
    ds_read_b64_tr_b16 a[236:237], v20 offset:32768
    ds_read_b64_tr_b16 a[238:239], v20 offset:47104
    s_waitcnt lgkmcnt(11)
    v_mfma_f32_16x16x32_bf16 v[128:131], a[224:227], a[192:195], 0
    ds_read_b64_tr_b16 a[240:241], v21 offset:0
    ds_read_b64_tr_b16 a[242:243], v21 offset:14336
    s_waitcnt lgkmcnt(12)
    v_mfma_f32_16x16x32_bf16 v[128:131], a[228:231], a[208:211], v[128:131]
    ds_read_b64_tr_b16 a[244:245], v21 offset:32768
    ds_read_b64_tr_b16 a[246:247], v21 offset:47104
    s_waitcnt lgkmcnt(12)
    v_mfma_f32_16x16x32_bf16 v[132:135], a[228:231], a[212:215], 0
    ds_read_b64_tr_b16 a[248:249], v22 offset:0
    ds_read_b64_tr_b16 a[250:251], v22 offset:14336
    v_mfma_f32_16x16x32_bf16 v[132:135], a[224:227], a[196:199], v[132:135]
    ds_read_b64_tr_b16 a[252:253], v22 offset:32768
    ds_read_b64_tr_b16 a[254:255], v22 offset:47104
    s_waitcnt lgkmcnt(14)
    v_mfma_f32_16x16x32_bf16 v[136:139], a[224:227], a[200:203], 0
    s_waitcnt lgkmcnt(14)
    v_mfma_f32_16x16x32_bf16 v[136:139], a[228:231], a[216:219], v[136:139]
    s_waitcnt lgkmcnt(12)
    v_mfma_f32_16x16x32_bf16 v[140:143], a[228:231], a[220:223], 0
    s_add_u32 m0, s67, 114688
    s_add_u32 s66, s81, 196608
    buffer_load_dwordx4 v4, s[16:19], s66 offen offset:0 nt lds
    v_mfma_f32_16x16x32_bf16 v[140:143], a[224:227], a[204:207], v[140:143]
    s_waitcnt lgkmcnt(10)
    v_mfma_f32_16x16x32_bf16 v[156:159], a[232:235], a[204:207], 0
    s_waitcnt lgkmcnt(8)
    v_mfma_f32_16x16x32_bf16 v[156:159], a[236:239], a[220:223], v[156:159]
    buffer_load_dwordx4 v4, s[16:19], s66 offen offset:1024 nt lds
    v_mfma_f32_16x16x32_bf16 v[152:155], a[236:239], a[216:219], 0
    v_mfma_f32_16x16x32_bf16 v[152:155], a[232:235], a[200:203], v[152:155]
    v_mfma_f32_16x16x32_bf16 v[148:151], a[232:235], a[196:199], 0
    buffer_load_dwordx4 v4, s[16:19], s66 offen offset:2048 nt lds
    v_mfma_f32_16x16x32_bf16 v[148:151], a[236:239], a[212:215], v[148:151]
    v_mfma_f32_16x16x32_bf16 v[144:147], a[236:239], a[208:211], 0
    v_mfma_f32_16x16x32_bf16 v[144:147], a[232:235], a[192:195], v[144:147]
    buffer_load_dwordx4 v4, s[16:19], s66 offen offset:3072 nt lds
    s_waitcnt vmcnt(16) lgkmcnt(0)
    v_mfma_f32_16x16x32_bf16 v[160:163], a[240:243], a[192:195], 0
    ds_read_b64_tr_b16 a[224:225], v19 offset:128
    ds_read_b64_tr_b16 a[226:227], v19 offset:14464
    v_mfma_f32_16x16x32_bf16 v[160:163], a[244:247], a[208:211], v[160:163]
    ds_read_b64_tr_b16 a[228:229], v19 offset:32896
    ds_read_b64_tr_b16 a[230:231], v19 offset:47232
    v_mfma_f32_16x16x32_bf16 v[164:167], a[244:247], a[212:215], 0
    ds_read_b64_tr_b16 a[232:233], v20 offset:128
    ds_read_b64_tr_b16 a[234:235], v20 offset:14464
    v_mfma_f32_16x16x32_bf16 v[164:167], a[240:243], a[196:199], v[164:167]
    ds_read_b64_tr_b16 a[236:237], v20 offset:32896
    ds_read_b64_tr_b16 a[238:239], v20 offset:47232
    v_mfma_f32_16x16x32_bf16 v[168:171], a[240:243], a[200:203], 0
    v_mfma_f32_16x16x32_bf16 v[168:171], a[244:247], a[216:219], v[168:171]
    v_mfma_f32_16x16x32_bf16 v[172:175], a[244:247], a[220:223], 0
    v_mfma_f32_16x16x32_bf16 v[172:175], a[240:243], a[204:207], v[172:175]
    v_mfma_f32_16x16x32_bf16 v[188:191], a[248:251], a[204:207], 0
    v_mfma_f32_16x16x32_bf16 v[188:191], a[252:255], a[220:223], v[188:191]
    v_mfma_f32_16x16x32_bf16 v[184:187], a[252:255], a[216:219], 0
    v_mfma_f32_16x16x32_bf16 v[184:187], a[248:251], a[200:203], v[184:187]
    v_mfma_f32_16x16x32_bf16 v[180:183], a[248:251], a[196:199], 0
    v_mfma_f32_16x16x32_bf16 v[180:183], a[252:255], a[212:215], v[180:183]
    v_mfma_f32_16x16x32_bf16 v[176:179], a[252:255], a[208:211], 0
    v_mfma_f32_16x16x32_bf16 v[176:179], a[248:251], a[192:195], v[176:179]
    s_waitcnt vmcnt(16) lgkmcnt(0)
    v_mfma_f32_16x16x32_bf16 v[192:195], a[224:227], a[192:195], 0
    ds_read_b64_tr_b16 a[240:241], v21 offset:128
    ds_read_b64_tr_b16 a[242:243], v21 offset:14464
    v_mfma_f32_16x16x32_bf16 v[192:195], a[228:231], a[208:211], v[192:195]
    ds_read_b64_tr_b16 a[244:245], v21 offset:32896
    ds_read_b64_tr_b16 a[246:247], v21 offset:47232
    v_mfma_f32_16x16x32_bf16 v[196:199], a[228:231], a[212:215], 0
    v_mfma_f32_16x16x32_bf16 v[196:199], a[224:227], a[196:199], v[196:199]
    v_mfma_f32_16x16x32_bf16 v[200:203], a[224:227], a[200:203], 0
    v_mfma_f32_16x16x32_bf16 v[200:203], a[228:231], a[216:219], v[200:203]
    v_mfma_f32_16x16x32_bf16 v[204:207], a[228:231], a[220:223], 0
    v_mfma_f32_16x16x32_bf16 v[204:207], a[224:227], a[204:207], v[204:207]
    v_mfma_f32_16x16x32_bf16 v[220:223], a[232:235], a[204:207], 0
    v_mfma_f32_16x16x32_bf16 v[220:223], a[236:239], a[220:223], v[220:223]
    v_mfma_f32_16x16x32_bf16 v[216:219], a[236:239], a[216:219], 0
    v_mfma_f32_16x16x32_bf16 v[216:219], a[232:235], a[200:203], v[216:219]
    v_mfma_f32_16x16x32_bf16 v[212:215], a[232:235], a[196:199], 0
    v_mfma_f32_16x16x32_bf16 v[212:215], a[236:239], a[212:215], v[212:215]
    v_mfma_f32_16x16x32_bf16 v[208:211], a[236:239], a[208:211], 0
    v_mfma_f32_16x16x32_bf16 v[208:211], a[232:235], a[192:195], v[208:211]
    s_waitcnt vmcnt(12) lgkmcnt(0)
    s_barrier
    v_mfma_f32_16x16x32_bf16 v[224:227], a[240:243], a[192:195], 0
    ds_read_b64_tr_b16 a[224:225], v15 offset:0
    ds_read_b64_tr_b16 a[226:227], v15 offset:2048
    v_mfma_f32_16x16x32_bf16 v[224:227], a[244:247], a[208:211], v[224:227]
    ds_read_b64_tr_b16 a[228:229], v16 offset:0
    ds_read_b64_tr_b16 a[230:231], v16 offset:2048
    v_mfma_f32_16x16x32_bf16 v[228:231], a[244:247], a[212:215], 0
    ds_read_b64_tr_b16 a[232:233], v17 offset:0
    ds_read_b64_tr_b16 a[234:235], v17 offset:2048
    v_mfma_f32_16x16x32_bf16 v[228:231], a[240:243], a[196:199], v[228:231]
    ds_read_b64_tr_b16 a[236:237], v18 offset:0
    ds_read_b64_tr_b16 a[238:239], v18 offset:2048
    v_mfma_f32_16x16x32_bf16 v[232:235], a[240:243], a[200:203], 0
    v_mfma_f32_16x16x32_bf16 v[232:235], a[244:247], a[216:219], v[232:235]
    v_mfma_f32_16x16x32_bf16 v[236:239], a[244:247], a[220:223], 0
    v_mfma_f32_16x16x32_bf16 v[236:239], a[240:243], a[204:207], v[236:239]
    s_waitcnt vmcnt(8) lgkmcnt(0)
    s_barrier
    v_mfma_f32_16x16x32_bf16 v[48:51], a[224:227], v[64:67], 0
    ds_read_b64_tr_b16 a[240:241], v15 offset:16384
    ds_read_b64_tr_b16 a[242:243], v15 offset:18432
    v_mfma_f32_16x16x32_bf16 v[48:51], a[228:231], a[0:3], v[48:51]
    ds_read_b64_tr_b16 a[244:245], v16 offset:16384
    ds_read_b64_tr_b16 a[246:247], v16 offset:18432
    v_mfma_f32_16x16x32_bf16 v[48:51], a[232:235], a[16:19], v[48:51]
    ds_read_b64_tr_b16 a[248:249], v17 offset:16384
    ds_read_b64_tr_b16 a[250:251], v17 offset:18432
    v_mfma_f32_16x16x32_bf16 v[48:51], a[236:239], a[32:35], v[48:51]
    ds_read_b64_tr_b16 a[252:253], v18 offset:16384
    ds_read_b64_tr_b16 a[254:255], v18 offset:18432
    v_mfma_f32_16x16x32_bf16 v[52:55], a[236:239], a[36:39], 0
    v_mfma_f32_16x16x32_bf16 v[52:55], a[232:235], a[20:23], v[52:55]
    v_mfma_f32_16x16x32_bf16 v[52:55], a[228:231], a[4:7], v[52:55]
    s_add_u32 m0, s68, 0
    s_add_u32 s66, s76, s85
    buffer_load_dwordx4 v5, s[24:27], s66 offen  lds
    v_mfma_f32_16x16x32_bf16 v[52:55], a[224:227], v[68:71], v[52:55]
    v_mfma_f32_16x16x32_bf16 v[56:59], a[224:227], v[72:75], 0
    v_mfma_f32_16x16x32_bf16 v[56:59], a[228:231], a[8:11], v[56:59]
    s_add_u32 m0, s68, 4096
    s_nop 0
    buffer_load_dwordx4 v6, s[24:27], s66 offen  lds
    v_mfma_f32_16x16x32_bf16 v[56:59], a[232:235], a[24:27], v[56:59]
    v_mfma_f32_16x16x32_bf16 v[56:59], a[236:239], a[40:43], v[56:59]
    v_mfma_f32_16x16x32_bf16 v[60:63], a[236:239], a[44:47], 0
    s_add_u32 m0, s68, 8192
    s_nop 0
    buffer_load_dwordx4 v7, s[24:27], s66 offen  lds
    v_mfma_f32_16x16x32_bf16 v[60:63], a[232:235], a[28:31], v[60:63]
    v_mfma_f32_16x16x32_bf16 v[60:63], a[228:231], a[12:15], v[60:63]
    v_mfma_f32_16x16x32_bf16 v[60:63], a[224:227], v[76:79], v[60:63]
    s_add_u32 m0, s68, 12288
    s_nop 0
    buffer_load_dwordx4 v8, s[24:27], s66 offen  lds
    s_and_b32 s5, s61, 14
    s_lshl_b32 s5, s5, 1
    s_mul_i32 s6, s58, 7
    s_sub_i32 s75, s5, s6
    s_min_i32 s5, s75, 7
    s_lshl1_add_u32 s5, s5, 42
    s_lshl_b32 s6, 0x55, s69
    s_mov_b32 s7, 0
    s_lshl_b64 s[6:7], s[6:7], s5
    s_bfe_u32 s74, s7, 0xe000a
    s_waitcnt vmcnt(8) lgkmcnt(0)
    s_barrier
    v_mfma_f32_16x16x32_bf16 v[48:51], a[240:243], v[80:83], v[48:51]
    s_add_u32 m0, s68, 16384
    s_nop 0
    buffer_load_dwordx4 v9, s[24:27], s66 offen  lds
    v_mfma_f32_16x16x32_bf16 v[48:51], a[244:247], a[48:51], v[48:51]
    ds_read_b64_tr_b16 a[224:225], v15 offset:32768
    ds_read_b64_tr_b16 a[226:227], v15 offset:34816
    v_mfma_f32_16x16x32_bf16 v[48:51], a[248:251], a[64:67], v[48:51]
    s_add_u32 m0, s68, 20480
    s_nop 0
    buffer_load_dwordx4 v10, s[24:27], s66 offen  lds
    v_mfma_f32_16x16x32_bf16 v[48:51], a[252:255], a[80:83], v[48:51]
    ds_read_b64_tr_b16 a[228:229], v16 offset:32768
    ds_read_b64_tr_b16 a[230:231], v16 offset:34816
    v_mfma_f32_16x16x32_bf16 v[52:55], a[252:255], a[84:87], v[52:55]
    s_add_u32 m0, s68, 24576
    s_nop 0
    buffer_load_dwordx4 v11, s[24:27], s66 offen  lds
    v_mfma_f32_16x16x32_bf16 v[52:55], a[248:251], a[68:71], v[52:55]
    ds_read_b64_tr_b16 a[232:233], v17 offset:32768
    ds_read_b64_tr_b16 a[234:235], v17 offset:34816
    v_mfma_f32_16x16x32_bf16 v[52:55], a[244:247], a[52:55], v[52:55]
    ds_read_b64_tr_b16 a[236:237], v18 offset:32768
    ds_read_b64_tr_b16 a[238:239], v18 offset:34816
    v_mfma_f32_16x16x32_bf16 v[52:55], a[240:243], v[84:87], v[52:55]
    s_add_u32 m0, s68, 32768
    s_add_u32 s66, s77, s85
    buffer_load_dwordx4 v5, s[24:27], s66 offen  lds
    v_mfma_f32_16x16x32_bf16 v[56:59], a[240:243], v[88:91], v[56:59]
    v_mfma_f32_16x16x32_bf16 v[56:59], a[244:247], a[56:59], v[56:59]
    s_add_u32 m0, s68, 36864
    s_nop 0
    buffer_load_dwordx4 v6, s[24:27], s66 offen  lds
    v_mfma_f32_16x16x32_bf16 v[56:59], a[248:251], a[72:75], v[56:59]
    v_mfma_f32_16x16x32_bf16 v[56:59], a[252:255], a[88:91], v[56:59]
    v_mfma_f32_16x16x32_bf16 v[60:63], a[252:255], a[92:95], v[60:63]
    s_add_u32 m0, s68, 40960
    s_nop 0
    buffer_load_dwordx4 v7, s[24:27], s66 offen  lds
    v_mfma_f32_16x16x32_bf16 v[60:63], a[248:251], a[76:79], v[60:63]
    v_mfma_f32_16x16x32_bf16 v[60:63], a[244:247], a[60:63], v[60:63]
    s_add_u32 m0, s68, 45056
    s_nop 0
    buffer_load_dwordx4 v8, s[24:27], s66 offen  lds
    v_mfma_f32_16x16x32_bf16 v[60:63], a[240:243], v[92:95], v[60:63]
    s_waitcnt vmcnt(11) lgkmcnt(0)
    s_barrier
    v_mfma_f32_16x16x32_bf16 v[48:51], a[224:227], v[96:99], v[48:51]
    s_add_u32 m0, s68, 49152
    s_nop 0
    buffer_load_dwordx4 v9, s[24:27], s66 offen  lds
    v_mfma_f32_16x16x32_bf16 v[48:51], a[228:231], a[96:99], v[48:51]
    ds_read_b64_tr_b16 a[240:241], v15 offset:49152
    ds_read_b64_tr_b16 a[242:243], v15 offset:51200
    v_mfma_f32_16x16x32_bf16 v[48:51], a[232:235], a[112:115], v[48:51]
    s_add_u32 m0, s68, 53248
    s_nop 0
    buffer_load_dwordx4 v10, s[24:27], s66 offen  lds
    v_mfma_f32_16x16x32_bf16 v[48:51], a[236:239], a[128:131], v[48:51]
    ds_read_b64_tr_b16 a[244:245], v16 offset:49152
    ds_read_b64_tr_b16 a[246:247], v16 offset:51200
    v_mfma_f32_16x16x32_bf16 v[52:55], a[236:239], a[132:135], v[52:55]
    s_add_u32 m0, s68, 57344
    s_nop 0
    buffer_load_dwordx4 v11, s[24:27], s66 offen  lds
    v_mfma_f32_16x16x32_bf16 v[52:55], a[232:235], a[116:119], v[52:55]
    ds_read_b64_tr_b16 a[248:249], v17 offset:49152
    ds_read_b64_tr_b16 a[250:251], v17 offset:51200
    v_mfma_f32_16x16x32_bf16 v[52:55], a[228:231], a[100:103], v[52:55]
    ds_read_b64_tr_b16 a[252:253], v18 offset:49152
    ds_read_b64_tr_b16 a[254:255], v18 offset:51200
    v_mfma_f32_16x16x32_bf16 v[52:55], a[224:227], v[100:103], v[52:55]
    v_mfma_f32_16x16x32_bf16 v[56:59], a[224:227], v[104:107], v[56:59]
    v_mfma_f32_16x16x32_bf16 v[56:59], a[228:231], a[104:107], v[56:59]
    s_add_u32 m0, s67, 65536
    s_add_u32 s66, s82, 0
    buffer_load_dwordx4 v4, s[16:19], s66 offen offset:0 nt lds
    v_mfma_f32_16x16x32_bf16 v[56:59], a[232:235], a[120:123], v[56:59]
    v_mfma_f32_16x16x32_bf16 v[56:59], a[236:239], a[136:139], v[56:59]
    buffer_load_dwordx4 v4, s[16:19], s66 offen offset:1024 nt lds
    v_mfma_f32_16x16x32_bf16 v[60:63], a[236:239], a[140:143], v[60:63]
    v_mfma_f32_16x16x32_bf16 v[60:63], a[232:235], a[124:127], v[60:63]
    buffer_load_dwordx4 v4, s[16:19], s66 offen offset:2048 nt lds
    v_mfma_f32_16x16x32_bf16 v[60:63], a[228:231], a[108:111], v[60:63]
    v_mfma_f32_16x16x32_bf16 v[60:63], a[224:227], v[108:111], v[60:63]
    buffer_load_dwordx4 v4, s[16:19], s66 offen offset:3072 nt lds
    s_waitcnt vmcnt(18) lgkmcnt(0)
    v_mfma_f32_16x16x32_bf16 v[48:51], a[240:243], v[112:115], v[48:51]
    v_mfma_f32_16x16x32_bf16 v[48:51], a[244:247], a[144:147], v[48:51]
    v_mfma_f32_16x16x32_bf16 v[48:51], a[248:251], a[160:163], v[48:51]
    v_mfma_f32_16x16x32_bf16 v[48:51], a[252:255], a[176:179], v[48:51]
    v_mfma_f32_16x16x32_bf16 v[52:55], a[252:255], a[180:183], v[52:55]
    v_mfma_f32_16x16x32_bf16 v[52:55], a[248:251], a[164:167], v[52:55]
    v_mfma_f32_16x16x32_bf16 v[52:55], a[244:247], a[148:151], v[52:55]
    s_add_u32 m0, s67, 81920
    s_add_u32 s66, s82, 65536
    buffer_load_dwordx4 v4, s[16:19], s66 offen offset:0 nt lds
    v_mfma_f32_16x16x32_bf16 v[52:55], a[240:243], v[116:119], v[52:55]
    v_mfma_f32_16x16x32_bf16 v[56:59], a[240:243], v[120:123], v[56:59]
    v_mfma_f32_16x16x32_bf16 v[56:59], a[244:247], a[152:155], v[56:59]
    buffer_load_dwordx4 v4, s[16:19], s66 offen offset:1024 nt lds
    v_mfma_f32_16x16x32_bf16 v[56:59], a[248:251], a[168:171], v[56:59]
    v_mfma_f32_16x16x32_bf16 v[56:59], a[252:255], a[184:187], v[56:59]
    v_mfma_f32_16x16x32_bf16 v[60:63], a[252:255], a[188:191], v[60:63]
    buffer_load_dwordx4 v4, s[16:19], s66 offen offset:2048 nt lds
    v_mfma_f32_16x16x32_bf16 v[60:63], a[248:251], a[172:175], v[60:63]
    v_mfma_f32_16x16x32_bf16 v[60:63], a[244:247], a[156:159], v[60:63]
    v_mfma_f32_16x16x32_bf16 v[60:63], a[240:243], v[124:127], v[60:63]
    buffer_load_dwordx4 v4, s[16:19], s66 offen offset:3072 nt lds
    v_pk_mul_f32 v[48:49], v[48:49], v[32:33] op_sel:[0,0] op_sel_hi:[1,0]
    v_pk_mul_f32 v[50:51], v[50:51], v[32:33] op_sel:[0,0] op_sel_hi:[1,0]
    v_cvt_pk_bf16_f32 v40, v48, v49
    v_cvt_pk_bf16_f32 v41, v50, v51
    v_pk_mul_f32 v[52:53], v[52:53], v[32:33] op_sel:[0,1] op_sel_hi:[1,1]
    v_pk_mul_f32 v[54:55], v[54:55], v[32:33] op_sel:[0,1] op_sel_hi:[1,1]
    v_cvt_pk_bf16_f32 v42, v52, v53
    v_cvt_pk_bf16_f32 v43, v54, v55
    v_pk_mul_f32 v[56:57], v[56:57], v[34:35] op_sel:[0,0] op_sel_hi:[1,0]
    v_pk_mul_f32 v[58:59], v[58:59], v[34:35] op_sel:[0,0] op_sel_hi:[1,0]
    v_cvt_pk_bf16_f32 v44, v56, v57
    v_cvt_pk_bf16_f32 v45, v58, v59
    v_pk_mul_f32 v[60:61], v[60:61], v[34:35] op_sel:[0,1] op_sel_hi:[1,1]
    v_pk_mul_f32 v[62:63], v[62:63], v[34:35] op_sel:[0,1] op_sel_hi:[1,1]
    v_cvt_pk_bf16_f32 v46, v60, v61
    v_cvt_pk_bf16_f32 v47, v62, v63
    ds_write_b64 v28, v[40:41] offset:0
    ds_write_b64 v28, v[42:43] offset:1024
    ds_write_b64 v28, v[44:45] offset:2048
    ds_write_b64 v28, v[46:47] offset:3072
    s_waitcnt vmcnt(8) lgkmcnt(0)
    s_barrier
    ds_read_b64_tr_b16 a[224:225], v19 offset:0
    ds_read_b64_tr_b16 a[226:227], v19 offset:14336
    ds_read_b64_tr_b16 a[228:229], v19 offset:32768
    ds_read_b64_tr_b16 a[230:231], v19 offset:47104
    ds_read_b128 a[192:195], v29 offset:0
    ds_read_b128 a[208:211], v30 offset:0
    ds_read_b128 a[196:199], v29 offset:1024
    ds_read_b128 a[212:215], v30 offset:1024
    ds_read_b128 a[200:203], v29 offset:2048
    ds_read_b128 a[216:219], v30 offset:2048
    ds_read_b128 a[204:207], v29 offset:3072
    ds_read_b128 a[220:223], v30 offset:3072
    ds_read_b64_tr_b16 a[232:233], v20 offset:0
    ds_read_b64_tr_b16 a[234:235], v20 offset:14336
    ds_read_b64_tr_b16 a[236:237], v20 offset:32768
    ds_read_b64_tr_b16 a[238:239], v20 offset:47104
    s_waitcnt lgkmcnt(11)
    v_mfma_f32_16x16x32_bf16 v[128:131], a[224:227], a[192:195], v[128:131]
    ds_read_b64_tr_b16 a[240:241], v21 offset:0
    ds_read_b64_tr_b16 a[242:243], v21 offset:14336
    s_waitcnt lgkmcnt(12)
    v_mfma_f32_16x16x32_bf16 v[128:131], a[228:231], a[208:211], v[128:131]
    ds_read_b64_tr_b16 a[244:245], v21 offset:32768
    ds_read_b64_tr_b16 a[246:247], v21 offset:47104
    s_waitcnt lgkmcnt(12)
    v_mfma_f32_16x16x32_bf16 v[132:135], a[228:231], a[212:215], v[132:135]
    ds_read_b64_tr_b16 a[248:249], v22 offset:0
    ds_read_b64_tr_b16 a[250:251], v22 offset:14336
    v_mfma_f32_16x16x32_bf16 v[132:135], a[224:227], a[196:199], v[132:135]
    ds_read_b64_tr_b16 a[252:253], v22 offset:32768
    ds_read_b64_tr_b16 a[254:255], v22 offset:47104
    s_waitcnt lgkmcnt(14)
    v_mfma_f32_16x16x32_bf16 v[136:139], a[224:227], a[200:203], v[136:139]
    s_waitcnt lgkmcnt(14)
    v_mfma_f32_16x16x32_bf16 v[136:139], a[228:231], a[216:219], v[136:139]
    s_waitcnt lgkmcnt(12)
    v_mfma_f32_16x16x32_bf16 v[140:143], a[228:231], a[220:223], v[140:143]
    s_add_u32 m0, s67, 98304
    s_add_u32 s66, s82, 131072
    buffer_load_dwordx4 v4, s[16:19], s66 offen offset:0 nt lds
    v_mfma_f32_16x16x32_bf16 v[140:143], a[224:227], a[204:207], v[140:143]
    s_waitcnt lgkmcnt(10)
    v_mfma_f32_16x16x32_bf16 v[156:159], a[232:235], a[204:207], v[156:159]
    s_waitcnt lgkmcnt(8)
    v_mfma_f32_16x16x32_bf16 v[156:159], a[236:239], a[220:223], v[156:159]
    buffer_load_dwordx4 v4, s[16:19], s66 offen offset:1024 nt lds
    v_mfma_f32_16x16x32_bf16 v[152:155], a[236:239], a[216:219], v[152:155]
    v_mfma_f32_16x16x32_bf16 v[152:155], a[232:235], a[200:203], v[152:155]
    v_mfma_f32_16x16x32_bf16 v[148:151], a[232:235], a[196:199], v[148:151]
    buffer_load_dwordx4 v4, s[16:19], s66 offen offset:2048 nt lds
    v_mfma_f32_16x16x32_bf16 v[148:151], a[236:239], a[212:215], v[148:151]
    v_mfma_f32_16x16x32_bf16 v[144:147], a[236:239], a[208:211], v[144:147]
    v_mfma_f32_16x16x32_bf16 v[144:147], a[232:235], a[192:195], v[144:147]
    buffer_load_dwordx4 v4, s[16:19], s66 offen offset:3072 nt lds
    s_waitcnt vmcnt(12) lgkmcnt(0)
    v_mfma_f32_16x16x32_bf16 v[160:163], a[240:243], a[192:195], v[160:163]
    ds_read_b64_tr_b16 a[224:225], v19 offset:128
    ds_read_b64_tr_b16 a[226:227], v19 offset:14464
    v_mfma_f32_16x16x32_bf16 v[160:163], a[244:247], a[208:211], v[160:163]
    ds_read_b64_tr_b16 a[228:229], v19 offset:32896
    ds_read_b64_tr_b16 a[230:231], v19 offset:47232
    v_mfma_f32_16x16x32_bf16 v[164:167], a[244:247], a[212:215], v[164:167]
    ds_read_b64_tr_b16 a[232:233], v20 offset:128
    ds_read_b64_tr_b16 a[234:235], v20 offset:14464
    v_mfma_f32_16x16x32_bf16 v[164:167], a[240:243], a[196:199], v[164:167]
    ds_read_b64_tr_b16 a[236:237], v20 offset:32896
    ds_read_b64_tr_b16 a[238:239], v20 offset:47232
    v_mfma_f32_16x16x32_bf16 v[168:171], a[240:243], a[200:203], v[168:171]
    v_mfma_f32_16x16x32_bf16 v[168:171], a[244:247], a[216:219], v[168:171]
    v_mfma_f32_16x16x32_bf16 v[172:175], a[244:247], a[220:223], v[172:175]
    v_mfma_f32_16x16x32_bf16 v[172:175], a[240:243], a[204:207], v[172:175]
    v_mfma_f32_16x16x32_bf16 v[188:191], a[248:251], a[204:207], v[188:191]
    buffer_load_dword v36, off, s[8:11], 0 sc1
    v_mfma_f32_16x16x32_bf16 v[188:191], a[252:255], a[220:223], v[188:191]
    v_mfma_f32_16x16x32_bf16 v[184:187], a[252:255], a[216:219], v[184:187]
    v_mfma_f32_16x16x32_bf16 v[184:187], a[248:251], a[200:203], v[184:187]
    v_mfma_f32_16x16x32_bf16 v[180:183], a[248:251], a[196:199], v[180:183]
    v_mfma_f32_16x16x32_bf16 v[180:183], a[252:255], a[212:215], v[180:183]
    v_mfma_f32_16x16x32_bf16 v[176:179], a[252:255], a[208:211], v[176:179]
    v_mfma_f32_16x16x32_bf16 v[176:179], a[248:251], a[192:195], v[176:179]
    s_waitcnt vmcnt(13) lgkmcnt(0)
    v_mfma_f32_16x16x32_bf16 v[192:195], a[224:227], a[192:195], v[192:195]
    ds_read_b64_tr_b16 a[240:241], v21 offset:128
    ds_read_b64_tr_b16 a[242:243], v21 offset:14464
    v_mfma_f32_16x16x32_bf16 v[192:195], a[228:231], a[208:211], v[192:195]
    ds_read_b64_tr_b16 a[244:245], v21 offset:32896
    ds_read_b64_tr_b16 a[246:247], v21 offset:47232
    v_mfma_f32_16x16x32_bf16 v[196:199], a[228:231], a[212:215], v[196:199]
    v_mfma_f32_16x16x32_bf16 v[196:199], a[224:227], a[196:199], v[196:199]
    v_mfma_f32_16x16x32_bf16 v[200:203], a[224:227], a[200:203], v[200:203]
    v_mfma_f32_16x16x32_bf16 v[200:203], a[228:231], a[216:219], v[200:203]
    v_mfma_f32_16x16x32_bf16 v[204:207], a[228:231], a[220:223], v[204:207]
    s_add_u32 m0, s67, 114688
    s_add_u32 s66, s82, 196608
    buffer_load_dwordx4 v4, s[16:19], s66 offen offset:0 nt lds
    v_mfma_f32_16x16x32_bf16 v[204:207], a[224:227], a[204:207], v[204:207]
    v_mfma_f32_16x16x32_bf16 v[220:223], a[232:235], a[204:207], v[220:223]
    v_mfma_f32_16x16x32_bf16 v[220:223], a[236:239], a[220:223], v[220:223]
    buffer_load_dwordx4 v4, s[16:19], s66 offen offset:1024 nt lds
    v_mfma_f32_16x16x32_bf16 v[216:219], a[236:239], a[216:219], v[216:219]
    v_mfma_f32_16x16x32_bf16 v[216:219], a[232:235], a[200:203], v[216:219]
    v_mfma_f32_16x16x32_bf16 v[212:215], a[232:235], a[196:199], v[212:215]
    buffer_load_dwordx4 v4, s[16:19], s66 offen offset:2048 nt lds
    v_mfma_f32_16x16x32_bf16 v[212:215], a[236:239], a[212:215], v[212:215]
    v_mfma_f32_16x16x32_bf16 v[208:211], a[236:239], a[208:211], v[208:211]
    v_mfma_f32_16x16x32_bf16 v[208:211], a[232:235], a[192:195], v[208:211]
    buffer_load_dwordx4 v4, s[16:19], s66 offen offset:3072 nt lds
    s_waitcnt vmcnt(13) lgkmcnt(0)
    s_barrier
    v_mfma_f32_16x16x32_bf16 v[224:227], a[240:243], a[192:195], v[224:227]
    ds_read_b64_tr_b16 a[224:225], v15 offset:0
    ds_read_b64_tr_b16 a[226:227], v15 offset:2048
    v_mfma_f32_16x16x32_bf16 v[224:227], a[244:247], a[208:211], v[224:227]
    ds_read_b64_tr_b16 a[228:229], v16 offset:0
    ds_read_b64_tr_b16 a[230:231], v16 offset:2048
    v_mfma_f32_16x16x32_bf16 v[228:231], a[244:247], a[212:215], v[228:231]
    ds_read_b64_tr_b16 a[232:233], v17 offset:0
    ds_read_b64_tr_b16 a[234:235], v17 offset:2048
    v_mfma_f32_16x16x32_bf16 v[228:231], a[240:243], a[196:199], v[228:231]
    ds_read_b64_tr_b16 a[236:237], v18 offset:0
    ds_read_b64_tr_b16 a[238:239], v18 offset:2048
    v_mfma_f32_16x16x32_bf16 v[232:235], a[240:243], a[200:203], v[232:235]
    v_mfma_f32_16x16x32_bf16 v[232:235], a[244:247], a[216:219], v[232:235]
    v_mfma_f32_16x16x32_bf16 v[236:239], a[244:247], a[220:223], v[236:239]
    v_mfma_f32_16x16x32_bf16 v[236:239], a[240:243], a[204:207], v[236:239]
    s_add_u32 m0, s68, 0
    s_add_u32 s66, s76, s86
    buffer_load_dwordx4 v5, s[24:27], s66 offen  lds
    s_add_u32 m0, s68, 4096
    s_nop 0
    buffer_load_dwordx4 v6, s[24:27], s66 offen  lds
    s_add_u32 m0, s68, 8192
    s_nop 0
    buffer_load_dwordx4 v7, s[24:27], s66 offen  lds
    s_add_u32 m0, s68, 12288
    s_nop 0
    buffer_load_dwordx4 v8, s[24:27], s66 offen  lds
    s_waitcnt vmcnt(13) lgkmcnt(0)
    s_barrier
    v_mfma_f32_16x16x32_bf16 v[48:51], a[224:227], v[64:67], 0
    ds_read_b64_tr_b16 a[240:241], v15 offset:16384
    ds_read_b64_tr_b16 a[242:243], v15 offset:18432
    v_mfma_f32_16x16x32_bf16 v[48:51], a[228:231], a[0:3], v[48:51]
    ds_read_b64_tr_b16 a[244:245], v16 offset:16384
    ds_read_b64_tr_b16 a[246:247], v16 offset:18432
    v_mfma_f32_16x16x32_bf16 v[48:51], a[232:235], a[16:19], v[48:51]
    ds_read_b64_tr_b16 a[248:249], v17 offset:16384
    ds_read_b64_tr_b16 a[250:251], v17 offset:18432
    v_mfma_f32_16x16x32_bf16 v[48:51], a[236:239], a[32:35], v[48:51]
    ds_read_b64_tr_b16 a[252:253], v18 offset:16384
    ds_read_b64_tr_b16 a[254:255], v18 offset:18432
    v_mfma_f32_16x16x32_bf16 v[52:55], a[236:239], a[36:39], 0
    v_mfma_f32_16x16x32_bf16 v[52:55], a[232:235], a[20:23], v[52:55]
    v_mfma_f32_16x16x32_bf16 v[52:55], a[228:231], a[4:7], v[52:55]
    v_mfma_f32_16x16x32_bf16 v[52:55], a[224:227], v[68:71], v[52:55]
    v_mfma_f32_16x16x32_bf16 v[56:59], a[224:227], v[72:75], 0
    v_mfma_f32_16x16x32_bf16 v[56:59], a[228:231], a[8:11], v[56:59]
    s_add_u32 m0, s68, 16384
    s_nop 0
    buffer_load_dwordx4 v9, s[24:27], s66 offen  lds
    v_mfma_f32_16x16x32_bf16 v[56:59], a[232:235], a[24:27], v[56:59]
    v_mfma_f32_16x16x32_bf16 v[56:59], a[236:239], a[40:43], v[56:59]
    v_mfma_f32_16x16x32_bf16 v[60:63], a[236:239], a[44:47], 0
    s_add_u32 m0, s68, 20480
    s_nop 0
    buffer_load_dwordx4 v10, s[24:27], s66 offen  lds
    v_mfma_f32_16x16x32_bf16 v[60:63], a[232:235], a[28:31], v[60:63]
    v_mfma_f32_16x16x32_bf16 v[60:63], a[228:231], a[12:15], v[60:63]
    v_mfma_f32_16x16x32_bf16 v[60:63], a[224:227], v[76:79], v[60:63]
    s_add_u32 m0, s68, 24576
    s_nop 0
    buffer_load_dwordx4 v11, s[24:27], s66 offen  lds
    s_waitcnt vmcnt(12) lgkmcnt(0)
    s_barrier
    v_mfma_f32_16x16x32_bf16 v[48:51], a[240:243], v[80:83], v[48:51]
    ds_read_b64_tr_b16 a[224:225], v15 offset:32768
    ds_read_b64_tr_b16 a[226:227], v15 offset:34816
    v_mfma_f32_16x16x32_bf16 v[48:51], a[244:247], a[48:51], v[48:51]
    ds_read_b64_tr_b16 a[228:229], v16 offset:32768
    ds_read_b64_tr_b16 a[230:231], v16 offset:34816
    v_mfma_f32_16x16x32_bf16 v[48:51], a[248:251], a[64:67], v[48:51]
    s_add_u32 m0, s68, 32768
    s_add_u32 s66, s77, s86
    buffer_load_dwordx4 v5, s[24:27], s66 offen  lds
    v_mfma_f32_16x16x32_bf16 v[48:51], a[252:255], a[80:83], v[48:51]
    ds_read_b64_tr_b16 a[232:233], v17 offset:32768
    ds_read_b64_tr_b16 a[234:235], v17 offset:34816
    v_mfma_f32_16x16x32_bf16 v[52:55], a[252:255], a[84:87], v[52:55]
    ds_read_b64_tr_b16 a[236:237], v18 offset:32768
    ds_read_b64_tr_b16 a[238:239], v18 offset:34816
    v_mfma_f32_16x16x32_bf16 v[52:55], a[248:251], a[68:71], v[52:55]
    v_mfma_f32_16x16x32_bf16 v[52:55], a[244:247], a[52:55], v[52:55]
    s_add_u32 m0, s68, 36864
    s_nop 0
    buffer_load_dwordx4 v6, s[24:27], s66 offen  lds
    v_mfma_f32_16x16x32_bf16 v[52:55], a[240:243], v[84:87], v[52:55]
    v_mfma_f32_16x16x32_bf16 v[56:59], a[240:243], v[88:91], v[56:59]
    v_mfma_f32_16x16x32_bf16 v[56:59], a[244:247], a[56:59], v[56:59]
    v_mfma_f32_16x16x32_bf16 v[56:59], a[248:251], a[72:75], v[56:59]
    s_add_u32 m0, s68, 40960
    s_nop 0
    buffer_load_dwordx4 v7, s[24:27], s66 offen  lds
    v_mfma_f32_16x16x32_bf16 v[56:59], a[252:255], a[88:91], v[56:59]
    v_mfma_f32_16x16x32_bf16 v[60:63], a[252:255], a[92:95], v[60:63]
    v_mfma_f32_16x16x32_bf16 v[60:63], a[248:251], a[76:79], v[60:63]
    v_mfma_f32_16x16x32_bf16 v[60:63], a[244:247], a[60:63], v[60:63]
    s_add_u32 m0, s68, 45056
    s_nop 0
    buffer_load_dwordx4 v8, s[24:27], s66 offen  lds
    v_mfma_f32_16x16x32_bf16 v[60:63], a[240:243], v[92:95], v[60:63]
    s_waitcnt vmcnt(11) lgkmcnt(0)
    s_barrier
    v_mfma_f32_16x16x32_bf16 v[48:51], a[224:227], v[96:99], v[48:51]
    s_add_u32 m0, s68, 49152
    s_nop 0
    buffer_load_dwordx4 v9, s[24:27], s66 offen  lds
    v_mfma_f32_16x16x32_bf16 v[48:51], a[228:231], a[96:99], v[48:51]
    ds_read_b64_tr_b16 a[240:241], v15 offset:49152
    ds_read_b64_tr_b16 a[242:243], v15 offset:51200
    v_mfma_f32_16x16x32_bf16 v[48:51], a[232:235], a[112:115], v[48:51]
    s_add_u32 m0, s68, 53248
    s_nop 0
    buffer_load_dwordx4 v10, s[24:27], s66 offen  lds
    v_mfma_f32_16x16x32_bf16 v[48:51], a[236:239], a[128:131], v[48:51]
    ds_read_b64_tr_b16 a[244:245], v16 offset:49152
    ds_read_b64_tr_b16 a[246:247], v16 offset:51200
    v_mfma_f32_16x16x32_bf16 v[52:55], a[236:239], a[132:135], v[52:55]
    s_add_u32 m0, s68, 57344
    s_nop 0
    buffer_load_dwordx4 v11, s[24:27], s66 offen  lds
    v_mfma_f32_16x16x32_bf16 v[52:55], a[232:235], a[116:119], v[52:55]
    ds_read_b64_tr_b16 a[248:249], v17 offset:49152
    ds_read_b64_tr_b16 a[250:251], v17 offset:51200
    v_mfma_f32_16x16x32_bf16 v[52:55], a[228:231], a[100:103], v[52:55]
    ds_read_b64_tr_b16 a[252:253], v18 offset:49152
    ds_read_b64_tr_b16 a[254:255], v18 offset:51200
    v_mfma_f32_16x16x32_bf16 v[52:55], a[224:227], v[100:103], v[52:55]
    v_mfma_f32_16x16x32_bf16 v[56:59], a[224:227], v[104:107], v[56:59]
    v_mfma_f32_16x16x32_bf16 v[56:59], a[228:231], a[104:107], v[56:59]
    s_add_u32 m0, s67, 65536
    s_add_u32 s66, s83, 0
    buffer_load_dwordx4 v4, s[16:19], s66 offen offset:0 nt lds
    v_mfma_f32_16x16x32_bf16 v[56:59], a[232:235], a[120:123], v[56:59]
    v_mfma_f32_16x16x32_bf16 v[56:59], a[236:239], a[136:139], v[56:59]
    buffer_load_dwordx4 v4, s[16:19], s66 offen offset:1024 nt lds
    v_mfma_f32_16x16x32_bf16 v[60:63], a[236:239], a[140:143], v[60:63]
    v_mfma_f32_16x16x32_bf16 v[60:63], a[232:235], a[124:127], v[60:63]
    buffer_load_dwordx4 v4, s[16:19], s66 offen offset:2048 nt lds
    v_mfma_f32_16x16x32_bf16 v[60:63], a[228:231], a[108:111], v[60:63]
    v_mfma_f32_16x16x32_bf16 v[60:63], a[224:227], v[108:111], v[60:63]
    buffer_load_dwordx4 v4, s[16:19], s66 offen offset:3072 nt lds
    s_waitcnt vmcnt(18) lgkmcnt(0)
    v_mfma_f32_16x16x32_bf16 v[48:51], a[240:243], v[112:115], v[48:51]
    v_mfma_f32_16x16x32_bf16 v[48:51], a[244:247], a[144:147], v[48:51]
    v_mfma_f32_16x16x32_bf16 v[48:51], a[248:251], a[160:163], v[48:51]
    v_mfma_f32_16x16x32_bf16 v[48:51], a[252:255], a[176:179], v[48:51]
    v_mfma_f32_16x16x32_bf16 v[52:55], a[252:255], a[180:183], v[52:55]
    v_mfma_f32_16x16x32_bf16 v[52:55], a[248:251], a[164:167], v[52:55]
    v_mfma_f32_16x16x32_bf16 v[52:55], a[244:247], a[148:151], v[52:55]
    s_add_u32 m0, s67, 81920
    s_add_u32 s66, s83, 65536
    buffer_load_dwordx4 v4, s[16:19], s66 offen offset:0 nt lds
    v_mfma_f32_16x16x32_bf16 v[52:55], a[240:243], v[116:119], v[52:55]
    v_mfma_f32_16x16x32_bf16 v[56:59], a[240:243], v[120:123], v[56:59]
    v_mfma_f32_16x16x32_bf16 v[56:59], a[244:247], a[152:155], v[56:59]
    buffer_load_dwordx4 v4, s[16:19], s66 offen offset:1024 nt lds
    v_mfma_f32_16x16x32_bf16 v[56:59], a[248:251], a[168:171], v[56:59]
    v_mfma_f32_16x16x32_bf16 v[56:59], a[252:255], a[184:187], v[56:59]
    v_mfma_f32_16x16x32_bf16 v[60:63], a[252:255], a[188:191], v[60:63]
    buffer_load_dwordx4 v4, s[16:19], s66 offen offset:2048 nt lds
    v_mfma_f32_16x16x32_bf16 v[60:63], a[248:251], a[172:175], v[60:63]
    v_mfma_f32_16x16x32_bf16 v[60:63], a[244:247], a[156:159], v[60:63]
    v_mfma_f32_16x16x32_bf16 v[60:63], a[240:243], v[124:127], v[60:63]
    buffer_load_dwordx4 v4, s[16:19], s66 offen offset:3072 nt lds
    v_pk_mul_f32 v[48:49], v[48:49], v[32:33] op_sel:[0,0] op_sel_hi:[1,0]
    v_pk_mul_f32 v[50:51], v[50:51], v[32:33] op_sel:[0,0] op_sel_hi:[1,0]
    v_cvt_pk_bf16_f32 v40, v48, v49
    v_cvt_pk_bf16_f32 v41, v50, v51
    v_pk_mul_f32 v[52:53], v[52:53], v[32:33] op_sel:[0,1] op_sel_hi:[1,1]
    v_pk_mul_f32 v[54:55], v[54:55], v[32:33] op_sel:[0,1] op_sel_hi:[1,1]
    v_cvt_pk_bf16_f32 v42, v52, v53
    v_cvt_pk_bf16_f32 v43, v54, v55
    v_pk_mul_f32 v[56:57], v[56:57], v[34:35] op_sel:[0,0] op_sel_hi:[1,0]
    v_pk_mul_f32 v[58:59], v[58:59], v[34:35] op_sel:[0,0] op_sel_hi:[1,0]
    v_cvt_pk_bf16_f32 v44, v56, v57
    v_cvt_pk_bf16_f32 v45, v58, v59
    v_pk_mul_f32 v[60:61], v[60:61], v[34:35] op_sel:[0,1] op_sel_hi:[1,1]
    v_pk_mul_f32 v[62:63], v[62:63], v[34:35] op_sel:[0,1] op_sel_hi:[1,1]
    v_cvt_pk_bf16_f32 v46, v60, v61
    v_cvt_pk_bf16_f32 v47, v62, v63
    ds_write_b64 v28, v[40:41] offset:0
    ds_write_b64 v28, v[42:43] offset:1024
    ds_write_b64 v28, v[44:45] offset:2048
    ds_write_b64 v28, v[46:47] offset:3072
    s_waitcnt vmcnt(8) lgkmcnt(0)
    s_barrier
    ds_read_b64_tr_b16 a[224:225], v19 offset:0
    ds_read_b64_tr_b16 a[226:227], v19 offset:14336
    ds_read_b64_tr_b16 a[228:229], v19 offset:32768
    ds_read_b64_tr_b16 a[230:231], v19 offset:47104
    ds_read_b128 a[192:195], v29 offset:0
    ds_read_b128 a[208:211], v30 offset:0
    ds_read_b128 a[196:199], v29 offset:1024
    ds_read_b128 a[212:215], v30 offset:1024
    ds_read_b128 a[200:203], v29 offset:2048
    ds_read_b128 a[216:219], v30 offset:2048
    ds_read_b128 a[204:207], v29 offset:3072
    ds_read_b128 a[220:223], v30 offset:3072
    ds_read_b64_tr_b16 a[232:233], v20 offset:0
    ds_read_b64_tr_b16 a[234:235], v20 offset:14336
    ds_read_b64_tr_b16 a[236:237], v20 offset:32768
    ds_read_b64_tr_b16 a[238:239], v20 offset:47104
    s_waitcnt lgkmcnt(11)
    v_mfma_f32_16x16x32_bf16 v[128:131], a[224:227], a[192:195], v[128:131]
    ds_read_b64_tr_b16 a[240:241], v21 offset:0
    ds_read_b64_tr_b16 a[242:243], v21 offset:14336
    s_waitcnt lgkmcnt(12)
    v_mfma_f32_16x16x32_bf16 v[128:131], a[228:231], a[208:211], v[128:131]
    ds_read_b64_tr_b16 a[244:245], v21 offset:32768
    ds_read_b64_tr_b16 a[246:247], v21 offset:47104
    s_waitcnt lgkmcnt(12)
    v_mfma_f32_16x16x32_bf16 v[132:135], a[228:231], a[212:215], v[132:135]
    ds_read_b64_tr_b16 a[248:249], v22 offset:0
    ds_read_b64_tr_b16 a[250:251], v22 offset:14336
    v_mfma_f32_16x16x32_bf16 v[132:135], a[224:227], a[196:199], v[132:135]
    ds_read_b64_tr_b16 a[252:253], v22 offset:32768
    ds_read_b64_tr_b16 a[254:255], v22 offset:47104
    s_waitcnt lgkmcnt(14)
    v_mfma_f32_16x16x32_bf16 v[136:139], a[224:227], a[200:203], v[136:139]
    s_waitcnt lgkmcnt(14)
    v_mfma_f32_16x16x32_bf16 v[136:139], a[228:231], a[216:219], v[136:139]
    s_waitcnt lgkmcnt(12)
    v_mfma_f32_16x16x32_bf16 v[140:143], a[228:231], a[220:223], v[140:143]
    s_add_u32 m0, s67, 98304
    s_add_u32 s66, s83, 131072
    buffer_load_dwordx4 v4, s[16:19], s66 offen offset:0 nt lds
    v_mfma_f32_16x16x32_bf16 v[140:143], a[224:227], a[204:207], v[140:143]
    s_waitcnt lgkmcnt(10)
    v_mfma_f32_16x16x32_bf16 v[156:159], a[232:235], a[204:207], v[156:159]
    s_waitcnt lgkmcnt(8)
    v_mfma_f32_16x16x32_bf16 v[156:159], a[236:239], a[220:223], v[156:159]
    buffer_load_dwordx4 v4, s[16:19], s66 offen offset:1024 nt lds
    v_mfma_f32_16x16x32_bf16 v[152:155], a[236:239], a[216:219], v[152:155]
    v_mfma_f32_16x16x32_bf16 v[152:155], a[232:235], a[200:203], v[152:155]
    v_mfma_f32_16x16x32_bf16 v[148:151], a[232:235], a[196:199], v[148:151]
    buffer_load_dwordx4 v4, s[16:19], s66 offen offset:2048 nt lds
    v_mfma_f32_16x16x32_bf16 v[148:151], a[236:239], a[212:215], v[148:151]
    v_mfma_f32_16x16x32_bf16 v[144:147], a[236:239], a[208:211], v[144:147]
    v_mfma_f32_16x16x32_bf16 v[144:147], a[232:235], a[192:195], v[144:147]
    buffer_load_dwordx4 v4, s[16:19], s66 offen offset:3072 nt lds
    s_waitcnt vmcnt(12) lgkmcnt(0)
    v_mfma_f32_16x16x32_bf16 v[160:163], a[240:243], a[192:195], v[160:163]
    ds_read_b64_tr_b16 a[224:225], v19 offset:128
    ds_read_b64_tr_b16 a[226:227], v19 offset:14464
    v_mfma_f32_16x16x32_bf16 v[160:163], a[244:247], a[208:211], v[160:163]
    ds_read_b64_tr_b16 a[228:229], v19 offset:32896
    ds_read_b64_tr_b16 a[230:231], v19 offset:47232
    v_mfma_f32_16x16x32_bf16 v[164:167], a[244:247], a[212:215], v[164:167]
    ds_read_b64_tr_b16 a[232:233], v20 offset:128
    ds_read_b64_tr_b16 a[234:235], v20 offset:14464
    v_mfma_f32_16x16x32_bf16 v[164:167], a[240:243], a[196:199], v[164:167]
    ds_read_b64_tr_b16 a[236:237], v20 offset:32896
    ds_read_b64_tr_b16 a[238:239], v20 offset:47232
    v_mfma_f32_16x16x32_bf16 v[168:171], a[240:243], a[200:203], v[168:171]
    v_mfma_f32_16x16x32_bf16 v[168:171], a[244:247], a[216:219], v[168:171]
    v_mfma_f32_16x16x32_bf16 v[172:175], a[244:247], a[220:223], v[172:175]
    v_mfma_f32_16x16x32_bf16 v[172:175], a[240:243], a[204:207], v[172:175]
    v_mfma_f32_16x16x32_bf16 v[188:191], a[248:251], a[204:207], v[188:191]
    v_mfma_f32_16x16x32_bf16 v[188:191], a[252:255], a[220:223], v[188:191]
    v_mfma_f32_16x16x32_bf16 v[184:187], a[252:255], a[216:219], v[184:187]
    v_mfma_f32_16x16x32_bf16 v[184:187], a[248:251], a[200:203], v[184:187]
    v_mfma_f32_16x16x32_bf16 v[180:183], a[248:251], a[196:199], v[180:183]
    v_mfma_f32_16x16x32_bf16 v[180:183], a[252:255], a[212:215], v[180:183]
    v_mfma_f32_16x16x32_bf16 v[176:179], a[252:255], a[208:211], v[176:179]
    v_mfma_f32_16x16x32_bf16 v[176:179], a[248:251], a[192:195], v[176:179]
    s_waitcnt vmcnt(12) lgkmcnt(0)
    v_mfma_f32_16x16x32_bf16 v[192:195], a[224:227], a[192:195], v[192:195]
    ds_read_b64_tr_b16 a[240:241], v21 offset:128
    ds_read_b64_tr_b16 a[242:243], v21 offset:14464
    v_mfma_f32_16x16x32_bf16 v[192:195], a[228:231], a[208:211], v[192:195]
    ds_read_b64_tr_b16 a[244:245], v21 offset:32896
    ds_read_b64_tr_b16 a[246:247], v21 offset:47232
    v_mfma_f32_16x16x32_bf16 v[196:199], a[228:231], a[212:215], v[196:199]
    v_mfma_f32_16x16x32_bf16 v[196:199], a[224:227], a[196:199], v[196:199]
    v_mfma_f32_16x16x32_bf16 v[200:203], a[224:227], a[200:203], v[200:203]
    v_mfma_f32_16x16x32_bf16 v[200:203], a[228:231], a[216:219], v[200:203]
    v_mfma_f32_16x16x32_bf16 v[204:207], a[228:231], a[220:223], v[204:207]
    s_add_u32 m0, s67, 114688
    s_add_u32 s66, s83, 196608
    buffer_load_dwordx4 v4, s[16:19], s66 offen offset:0 nt lds
    v_mfma_f32_16x16x32_bf16 v[204:207], a[224:227], a[204:207], v[204:207]
    v_mfma_f32_16x16x32_bf16 v[220:223], a[232:235], a[204:207], v[220:223]
    v_mfma_f32_16x16x32_bf16 v[220:223], a[236:239], a[220:223], v[220:223]
    buffer_load_dwordx4 v4, s[16:19], s66 offen offset:1024 nt lds
    v_mfma_f32_16x16x32_bf16 v[216:219], a[236:239], a[216:219], v[216:219]
    v_mfma_f32_16x16x32_bf16 v[216:219], a[232:235], a[200:203], v[216:219]
    v_mfma_f32_16x16x32_bf16 v[212:215], a[232:235], a[196:199], v[212:215]
    buffer_load_dwordx4 v4, s[16:19], s66 offen offset:2048 nt lds
    v_mfma_f32_16x16x32_bf16 v[212:215], a[236:239], a[212:215], v[212:215]
    v_mfma_f32_16x16x32_bf16 v[208:211], a[236:239], a[208:211], v[208:211]
    v_mfma_f32_16x16x32_bf16 v[208:211], a[232:235], a[192:195], v[208:211]
    buffer_load_dwordx4 v4, s[16:19], s66 offen offset:3072 nt lds
    s_waitcnt vmcnt(12) lgkmcnt(0)
    s_barrier
    v_mfma_f32_16x16x32_bf16 v[224:227], a[240:243], a[192:195], v[224:227]
    ds_read_b64_tr_b16 a[224:225], v15 offset:0
    ds_read_b64_tr_b16 a[226:227], v15 offset:2048
    v_mfma_f32_16x16x32_bf16 v[224:227], a[244:247], a[208:211], v[224:227]
    ds_read_b64_tr_b16 a[228:229], v16 offset:0
    ds_read_b64_tr_b16 a[230:231], v16 offset:2048
    v_mfma_f32_16x16x32_bf16 v[228:231], a[244:247], a[212:215], v[228:231]
    ds_read_b64_tr_b16 a[232:233], v17 offset:0
    ds_read_b64_tr_b16 a[234:235], v17 offset:2048
    v_mfma_f32_16x16x32_bf16 v[228:231], a[240:243], a[196:199], v[228:231]
    ds_read_b64_tr_b16 a[236:237], v18 offset:0
    ds_read_b64_tr_b16 a[238:239], v18 offset:2048
    v_mfma_f32_16x16x32_bf16 v[232:235], a[240:243], a[200:203], v[232:235]
    v_mfma_f32_16x16x32_bf16 v[232:235], a[244:247], a[216:219], v[232:235]
    v_mfma_f32_16x16x32_bf16 v[236:239], a[244:247], a[220:223], v[236:239]
    v_mfma_f32_16x16x32_bf16 v[236:239], a[240:243], a[204:207], v[236:239]
    s_add_u32 m0, s68, 0
    s_add_u32 s66, s76, s87
    buffer_load_dwordx4 v5, s[24:27], s66 offen  lds
    s_add_u32 m0, s68, 4096
    s_nop 0
    buffer_load_dwordx4 v6, s[24:27], s66 offen  lds
    s_add_u32 m0, s68, 8192
    s_nop 0
    buffer_load_dwordx4 v7, s[24:27], s66 offen  lds
    s_add_u32 m0, s68, 12288
    s_nop 0
    buffer_load_dwordx4 v8, s[24:27], s66 offen  lds
    s_waitcnt vmcnt(12) lgkmcnt(0)
    s_barrier
    v_mfma_f32_16x16x32_bf16 v[48:51], a[224:227], v[64:67], 0
    ds_read_b64_tr_b16 a[240:241], v15 offset:16384
    ds_read_b64_tr_b16 a[242:243], v15 offset:18432
    v_mfma_f32_16x16x32_bf16 v[48:51], a[228:231], a[0:3], v[48:51]
    ds_read_b64_tr_b16 a[244:245], v16 offset:16384
    ds_read_b64_tr_b16 a[246:247], v16 offset:18432
    v_mfma_f32_16x16x32_bf16 v[48:51], a[232:235], a[16:19], v[48:51]
    ds_read_b64_tr_b16 a[248:249], v17 offset:16384
    ds_read_b64_tr_b16 a[250:251], v17 offset:18432
    v_mfma_f32_16x16x32_bf16 v[48:51], a[236:239], a[32:35], v[48:51]
    ds_read_b64_tr_b16 a[252:253], v18 offset:16384
    ds_read_b64_tr_b16 a[254:255], v18 offset:18432
    v_mfma_f32_16x16x32_bf16 v[52:55], a[236:239], a[36:39], 0
    v_mfma_f32_16x16x32_bf16 v[52:55], a[232:235], a[20:23], v[52:55]
    v_mfma_f32_16x16x32_bf16 v[52:55], a[228:231], a[4:7], v[52:55]
    v_mfma_f32_16x16x32_bf16 v[52:55], a[224:227], v[68:71], v[52:55]
    v_mfma_f32_16x16x32_bf16 v[56:59], a[224:227], v[72:75], 0
    v_mfma_f32_16x16x32_bf16 v[56:59], a[228:231], a[8:11], v[56:59]
    s_add_u32 m0, s68, 16384
    s_nop 0
    buffer_load_dwordx4 v9, s[24:27], s66 offen  lds
    v_mfma_f32_16x16x32_bf16 v[56:59], a[232:235], a[24:27], v[56:59]
    v_mfma_f32_16x16x32_bf16 v[56:59], a[236:239], a[40:43], v[56:59]
    v_mfma_f32_16x16x32_bf16 v[60:63], a[236:239], a[44:47], 0
    s_add_u32 m0, s68, 20480
    s_nop 0
    buffer_load_dwordx4 v10, s[24:27], s66 offen  lds
    v_mfma_f32_16x16x32_bf16 v[60:63], a[232:235], a[28:31], v[60:63]
    v_mfma_f32_16x16x32_bf16 v[60:63], a[228:231], a[12:15], v[60:63]
    v_mfma_f32_16x16x32_bf16 v[60:63], a[224:227], v[76:79], v[60:63]
    s_add_u32 m0, s68, 24576
    s_nop 0
    buffer_load_dwordx4 v11, s[24:27], s66 offen  lds
    s_waitcnt vmcnt(11) lgkmcnt(0)
    s_barrier
    v_mfma_f32_16x16x32_bf16 v[48:51], a[240:243], v[80:83], v[48:51]
    ds_read_b64_tr_b16 a[224:225], v15 offset:32768
    ds_read_b64_tr_b16 a[226:227], v15 offset:34816
    v_mfma_f32_16x16x32_bf16 v[48:51], a[244:247], a[48:51], v[48:51]
    ds_read_b64_tr_b16 a[228:229], v16 offset:32768
    ds_read_b64_tr_b16 a[230:231], v16 offset:34816
    v_mfma_f32_16x16x32_bf16 v[48:51], a[248:251], a[64:67], v[48:51]
    s_add_u32 m0, s68, 32768
    s_add_u32 s66, s77, s87
    buffer_load_dwordx4 v5, s[24:27], s66 offen  lds
    v_mfma_f32_16x16x32_bf16 v[48:51], a[252:255], a[80:83], v[48:51]
    ds_read_b64_tr_b16 a[232:233], v17 offset:32768
    ds_read_b64_tr_b16 a[234:235], v17 offset:34816
    v_mfma_f32_16x16x32_bf16 v[52:55], a[252:255], a[84:87], v[52:55]
    ds_read_b64_tr_b16 a[236:237], v18 offset:32768
    ds_read_b64_tr_b16 a[238:239], v18 offset:34816
    v_mfma_f32_16x16x32_bf16 v[52:55], a[248:251], a[68:71], v[52:55]
    v_mfma_f32_16x16x32_bf16 v[52:55], a[244:247], a[52:55], v[52:55]
    s_add_u32 m0, s68, 36864
    s_nop 0
    buffer_load_dwordx4 v6, s[24:27], s66 offen  lds
    v_mfma_f32_16x16x32_bf16 v[52:55], a[240:243], v[84:87], v[52:55]
    v_mfma_f32_16x16x32_bf16 v[56:59], a[240:243], v[88:91], v[56:59]
    v_mfma_f32_16x16x32_bf16 v[56:59], a[244:247], a[56:59], v[56:59]
    v_mfma_f32_16x16x32_bf16 v[56:59], a[248:251], a[72:75], v[56:59]
    s_add_u32 m0, s68, 40960
    s_nop 0
    buffer_load_dwordx4 v7, s[24:27], s66 offen  lds
    v_mfma_f32_16x16x32_bf16 v[56:59], a[252:255], a[88:91], v[56:59]
    v_mfma_f32_16x16x32_bf16 v[60:63], a[252:255], a[92:95], v[60:63]
    v_mfma_f32_16x16x32_bf16 v[60:63], a[248:251], a[76:79], v[60:63]
    v_mfma_f32_16x16x32_bf16 v[60:63], a[244:247], a[60:63], v[60:63]
    s_add_u32 m0, s68, 45056
    s_nop 0
    buffer_load_dwordx4 v8, s[24:27], s66 offen  lds
    v_mfma_f32_16x16x32_bf16 v[60:63], a[240:243], v[92:95], v[60:63]
    s_waitcnt vmcnt(11) lgkmcnt(0)
    s_barrier
    v_mfma_f32_16x16x32_bf16 v[48:51], a[224:227], v[96:99], v[48:51]
    s_add_u32 m0, s68, 49152
    s_nop 0
    buffer_load_dwordx4 v9, s[24:27], s66 offen  lds
    v_mfma_f32_16x16x32_bf16 v[48:51], a[228:231], a[96:99], v[48:51]
    ds_read_b64_tr_b16 a[240:241], v15 offset:49152
    ds_read_b64_tr_b16 a[242:243], v15 offset:51200
    v_mfma_f32_16x16x32_bf16 v[48:51], a[232:235], a[112:115], v[48:51]
    ds_read_b64_tr_b16 a[244:245], v16 offset:49152
    ds_read_b64_tr_b16 a[246:247], v16 offset:51200
    v_mfma_f32_16x16x32_bf16 v[48:51], a[236:239], a[128:131], v[48:51]
    s_add_u32 m0, s68, 53248
    s_nop 0
    buffer_load_dwordx4 v10, s[24:27], s66 offen  lds
    v_mfma_f32_16x16x32_bf16 v[52:55], a[236:239], a[132:135], v[52:55]
    ds_read_b64_tr_b16 a[248:249], v17 offset:49152
    ds_read_b64_tr_b16 a[250:251], v17 offset:51200
    v_mfma_f32_16x16x32_bf16 v[52:55], a[232:235], a[116:119], v[52:55]
    ds_read_b64_tr_b16 a[252:253], v18 offset:49152
    ds_read_b64_tr_b16 a[254:255], v18 offset:51200
    v_mfma_f32_16x16x32_bf16 v[52:55], a[228:231], a[100:103], v[52:55]
    s_add_u32 m0, s68, 57344
    s_nop 0
    buffer_load_dwordx4 v11, s[24:27], s66 offen  lds
    v_mfma_f32_16x16x32_bf16 v[52:55], a[224:227], v[100:103], v[52:55]
    v_mfma_f32_16x16x32_bf16 v[56:59], a[224:227], v[104:107], v[56:59]
    v_mfma_f32_16x16x32_bf16 v[56:59], a[228:231], a[104:107], v[56:59]
    v_mfma_f32_16x16x32_bf16 v[56:59], a[232:235], a[120:123], v[56:59]
    v_mfma_f32_16x16x32_bf16 v[56:59], a[236:239], a[136:139], v[56:59]
    v_mfma_f32_16x16x32_bf16 v[60:63], a[236:239], a[140:143], v[60:63]
    v_mfma_f32_16x16x32_bf16 v[60:63], a[232:235], a[124:127], v[60:63]
    v_mfma_f32_16x16x32_bf16 v[60:63], a[228:231], a[108:111], v[60:63]
    v_mfma_f32_16x16x32_bf16 v[60:63], a[224:227], v[108:111], v[60:63]
    s_waitcnt lgkmcnt(0)
    v_mfma_f32_16x16x32_bf16 v[48:51], a[240:243], v[112:115], v[48:51]
    v_mfma_f32_16x16x32_bf16 v[48:51], a[244:247], a[144:147], v[48:51]
    v_mfma_f32_16x16x32_bf16 v[48:51], a[248:251], a[160:163], v[48:51]
    v_mfma_f32_16x16x32_bf16 v[48:51], a[252:255], a[176:179], v[48:51]
    v_mfma_f32_16x16x32_bf16 v[52:55], a[252:255], a[180:183], v[52:55]
    v_mfma_f32_16x16x32_bf16 v[52:55], a[248:251], a[164:167], v[52:55]
    v_mfma_f32_16x16x32_bf16 v[52:55], a[244:247], a[148:151], v[52:55]
    v_mfma_f32_16x16x32_bf16 v[52:55], a[240:243], v[116:119], v[52:55]
    v_mfma_f32_16x16x32_bf16 v[56:59], a[240:243], v[120:123], v[56:59]
    v_mfma_f32_16x16x32_bf16 v[56:59], a[244:247], a[152:155], v[56:59]
    v_mfma_f32_16x16x32_bf16 v[56:59], a[248:251], a[168:171], v[56:59]
    v_mfma_f32_16x16x32_bf16 v[56:59], a[252:255], a[184:187], v[56:59]
    v_mfma_f32_16x16x32_bf16 v[60:63], a[252:255], a[188:191], v[60:63]
    v_mfma_f32_16x16x32_bf16 v[60:63], a[248:251], a[172:175], v[60:63]
    v_mfma_f32_16x16x32_bf16 v[60:63], a[244:247], a[156:159], v[60:63]
    v_mfma_f32_16x16x32_bf16 v[60:63], a[240:243], v[124:127], v[60:63]
    v_pk_mul_f32 v[48:49], v[48:49], v[32:33] op_sel:[0,0] op_sel_hi:[1,0]
    v_pk_mul_f32 v[50:51], v[50:51], v[32:33] op_sel:[0,0] op_sel_hi:[1,0]
    v_cvt_pk_bf16_f32 v40, v48, v49
    v_cvt_pk_bf16_f32 v41, v50, v51
    v_pk_mul_f32 v[52:53], v[52:53], v[32:33] op_sel:[0,1] op_sel_hi:[1,1]
    v_pk_mul_f32 v[54:55], v[54:55], v[32:33] op_sel:[0,1] op_sel_hi:[1,1]
    v_cvt_pk_bf16_f32 v42, v52, v53
    v_cvt_pk_bf16_f32 v43, v54, v55
    v_pk_mul_f32 v[56:57], v[56:57], v[34:35] op_sel:[0,0] op_sel_hi:[1,0]
    v_pk_mul_f32 v[58:59], v[58:59], v[34:35] op_sel:[0,0] op_sel_hi:[1,0]
    v_cvt_pk_bf16_f32 v44, v56, v57
    v_cvt_pk_bf16_f32 v45, v58, v59
    v_pk_mul_f32 v[60:61], v[60:61], v[34:35] op_sel:[0,1] op_sel_hi:[1,1]
    v_pk_mul_f32 v[62:63], v[62:63], v[34:35] op_sel:[0,1] op_sel_hi:[1,1]
    v_cvt_pk_bf16_f32 v46, v60, v61
    v_cvt_pk_bf16_f32 v47, v62, v63
    ds_write_b64 v28, v[40:41] offset:0
    ds_write_b64 v28, v[42:43] offset:1024
    ds_write_b64 v28, v[44:45] offset:2048
    ds_write_b64 v28, v[46:47] offset:3072
    s_waitcnt vmcnt(0) lgkmcnt(0)
    s_barrier
    ds_read_b128 a[192:195], v29 offset:0
    ds_read_b128 a[208:211], v30 offset:0
    ds_read_b128 a[196:199], v29 offset:1024
    ds_read_b128 a[212:215], v30 offset:1024
    ds_read_b128 a[200:203], v29 offset:2048
    ds_read_b128 a[216:219], v30 offset:2048
    ds_read_b128 a[204:207], v29 offset:3072
    ds_read_b128 a[220:223], v30 offset:3072
    s_mov_b32 s65, 0x80000000
    ds_read_b64_tr_b16 a[224:225], v19 offset:0
    ds_read_b64_tr_b16 a[226:227], v19 offset:14336
    ds_read_b64_tr_b16 a[228:229], v19 offset:32768
    ds_read_b64_tr_b16 a[230:231], v19 offset:47104
    s_waitcnt lgkmcnt(0)
    v_mfma_f32_16x16x32_bf16 v[128:131], a[224:227], a[192:195], v[128:131]
    ds_read_b64_tr_b16 a[232:233], v20 offset:0
    ds_read_b64_tr_b16 a[234:235], v20 offset:14336
    v_mfma_f32_16x16x32_bf16 v[128:131], a[228:231], a[208:211], v[128:131]
    ds_read_b64_tr_b16 a[236:237], v20 offset:32768
    ds_read_b64_tr_b16 a[238:239], v20 offset:47104
    v_mfma_f32_16x16x32_bf16 v[132:135], a[228:231], a[212:215], v[132:135]
    v_mfma_f32_16x16x32_bf16 v[132:135], a[224:227], a[196:199], v[132:135]
    v_mfma_f32_16x16x32_bf16 v[136:139], a[224:227], a[200:203], v[136:139]
    v_mfma_f32_16x16x32_bf16 v[136:139], a[228:231], a[216:219], v[136:139]
    v_mfma_f32_16x16x32_bf16 v[140:143], a[228:231], a[220:223], v[140:143]
    v_mfma_f32_16x16x32_bf16 v[140:143], a[224:227], a[204:207], v[140:143]
    s_waitcnt lgkmcnt(0)
    v_mfma_f32_16x16x32_bf16 v[144:147], a[232:235], a[192:195], v[144:147]
    ds_read_b64_tr_b16 a[240:241], v21 offset:0
    ds_read_b64_tr_b16 a[242:243], v21 offset:14336
    v_mfma_f32_16x16x32_bf16 v[144:147], a[236:239], a[208:211], v[144:147]
    ds_read_b64_tr_b16 a[244:245], v21 offset:32768
    ds_read_b64_tr_b16 a[246:247], v21 offset:47104
    v_mfma_f32_16x16x32_bf16 v[148:151], a[236:239], a[212:215], v[148:151]
    v_cvt_pk_bf16_f32 v64, v128, v129
    v_cvt_pk_bf16_f32 v65, v130, v131
    v_mfma_f32_16x16x32_bf16 v[148:151], a[232:235], a[196:199], v[148:151]
    v_cvt_pk_bf16_f32 v66, v132, v133
    v_cvt_pk_bf16_f32 v67, v134, v135
    v_mfma_f32_16x16x32_bf16 v[152:155], a[232:235], a[200:203], v[152:155]
    s_bitcmp1_b32 s74, 0
    s_cselect_b32 s66, s65, 0
    buffer_store_dwordx4 v[64:67], v31, s[28:31], s66 offen offset:0 sc1
    v_mfma_f32_16x16x32_bf16 v[152:155], a[236:239], a[216:219], v[152:155]
    v_cvt_pk_bf16_f32 v68, v136, v137
    v_cvt_pk_bf16_f32 v69, v138, v139
    v_mfma_f32_16x16x32_bf16 v[156:159], a[236:239], a[220:223], v[156:159]
    v_cvt_pk_bf16_f32 v70, v140, v141
    v_cvt_pk_bf16_f32 v71, v142, v143
    v_mfma_f32_16x16x32_bf16 v[156:159], a[232:235], a[204:207], v[156:159]
    s_bitcmp1_b32 s74, 1
    s_cselect_b32 s66, s65, 0
    buffer_store_dwordx4 v[68:71], v31, s[28:31], s66 offen offset:1024 sc1
    s_waitcnt lgkmcnt(0)
    v_mfma_f32_16x16x32_bf16 v[160:163], a[240:243], a[192:195], v[160:163]
    ds_read_b64_tr_b16 a[224:225], v22 offset:0
    ds_read_b64_tr_b16 a[226:227], v22 offset:14336
    v_mfma_f32_16x16x32_bf16 v[160:163], a[244:247], a[208:211], v[160:163]
    ds_read_b64_tr_b16 a[228:229], v22 offset:32768
    ds_read_b64_tr_b16 a[230:231], v22 offset:47104
    v_mfma_f32_16x16x32_bf16 v[164:167], a[244:247], a[212:215], v[164:167]
    v_cvt_pk_bf16_f32 v72, v144, v145
    v_cvt_pk_bf16_f32 v73, v146, v147
    v_mfma_f32_16x16x32_bf16 v[164:167], a[240:243], a[196:199], v[164:167]
    v_cvt_pk_bf16_f32 v74, v148, v149
    v_cvt_pk_bf16_f32 v75, v150, v151
    v_mfma_f32_16x16x32_bf16 v[168:171], a[240:243], a[200:203], v[168:171]
    s_bitcmp1_b32 s74, 2
    s_cselect_b32 s66, s65, 0
    buffer_store_dwordx4 v[72:75], v31, s[28:31], s66 offen offset:2048 sc1
    v_mfma_f32_16x16x32_bf16 v[168:171], a[244:247], a[216:219], v[168:171]
    v_cvt_pk_bf16_f32 v76, v152, v153
    v_cvt_pk_bf16_f32 v77, v154, v155
    v_mfma_f32_16x16x32_bf16 v[172:175], a[244:247], a[220:223], v[172:175]
    v_cvt_pk_bf16_f32 v78, v156, v157
    v_cvt_pk_bf16_f32 v79, v158, v159
    v_mfma_f32_16x16x32_bf16 v[172:175], a[240:243], a[204:207], v[172:175]
    s_bitcmp1_b32 s74, 3
    s_cselect_b32 s66, s65, 0
    buffer_store_dwordx4 v[76:79], v31, s[28:31], s66 offen offset:3072 sc1
    s_waitcnt lgkmcnt(0)
    v_mfma_f32_16x16x32_bf16 v[176:179], a[224:227], a[192:195], v[176:179]
    ds_read_b64_tr_b16 a[232:233], v19 offset:128
    ds_read_b64_tr_b16 a[234:235], v19 offset:14464
    v_mfma_f32_16x16x32_bf16 v[176:179], a[228:231], a[208:211], v[176:179]
    ds_read_b64_tr_b16 a[236:237], v19 offset:32896
    ds_read_b64_tr_b16 a[238:239], v19 offset:47232
    v_mfma_f32_16x16x32_bf16 v[180:183], a[228:231], a[212:215], v[180:183]
    v_cvt_pk_bf16_f32 v80, v160, v161
    v_cvt_pk_bf16_f32 v81, v162, v163
    v_mfma_f32_16x16x32_bf16 v[180:183], a[224:227], a[196:199], v[180:183]
    v_cvt_pk_bf16_f32 v82, v164, v165
    v_cvt_pk_bf16_f32 v83, v166, v167
    v_mfma_f32_16x16x32_bf16 v[184:187], a[224:227], a[200:203], v[184:187]
    s_bitcmp1_b32 s74, 4
    s_cselect_b32 s66, s65, 4096
    buffer_store_dwordx4 v[80:83], v31, s[28:31], s66 offen offset:0 sc1
    v_mfma_f32_16x16x32_bf16 v[184:187], a[228:231], a[216:219], v[184:187]
    v_cvt_pk_bf16_f32 v84, v168, v169
    v_cvt_pk_bf16_f32 v85, v170, v171
    v_mfma_f32_16x16x32_bf16 v[188:191], a[228:231], a[220:223], v[188:191]
    v_cvt_pk_bf16_f32 v86, v172, v173
    v_cvt_pk_bf16_f32 v87, v174, v175
    v_mfma_f32_16x16x32_bf16 v[188:191], a[224:227], a[204:207], v[188:191]
    s_bitcmp1_b32 s74, 5
    s_cselect_b32 s66, s65, 4096
    buffer_store_dwordx4 v[84:87], v31, s[28:31], s66 offen offset:1024 sc1
    s_waitcnt lgkmcnt(0)
    v_mfma_f32_16x16x32_bf16 v[192:195], a[232:235], a[192:195], v[192:195]
    ds_read_b64_tr_b16 a[240:241], v20 offset:128
    ds_read_b64_tr_b16 a[242:243], v20 offset:14464
    v_mfma_f32_16x16x32_bf16 v[192:195], a[236:239], a[208:211], v[192:195]
    ds_read_b64_tr_b16 a[244:245], v20 offset:32896
    ds_read_b64_tr_b16 a[246:247], v20 offset:47232
    v_mfma_f32_16x16x32_bf16 v[196:199], a[236:239], a[212:215], v[196:199]
    v_cvt_pk_bf16_f32 v88, v176, v177
    v_cvt_pk_bf16_f32 v89, v178, v179
    v_mfma_f32_16x16x32_bf16 v[196:199], a[232:235], a[196:199], v[196:199]
    v_cvt_pk_bf16_f32 v90, v180, v181
    v_cvt_pk_bf16_f32 v91, v182, v183
    v_mfma_f32_16x16x32_bf16 v[200:203], a[232:235], a[200:203], v[200:203]
    s_bitcmp1_b32 s74, 6
    s_cselect_b32 s66, s65, 4096
    buffer_store_dwordx4 v[88:91], v31, s[28:31], s66 offen offset:2048 sc1
    v_mfma_f32_16x16x32_bf16 v[200:203], a[236:239], a[216:219], v[200:203]
    v_cvt_pk_bf16_f32 v92, v184, v185
    v_cvt_pk_bf16_f32 v93, v186, v187
    v_mfma_f32_16x16x32_bf16 v[204:207], a[236:239], a[220:223], v[204:207]
    v_cvt_pk_bf16_f32 v94, v188, v189
    v_cvt_pk_bf16_f32 v95, v190, v191
    v_mfma_f32_16x16x32_bf16 v[204:207], a[232:235], a[204:207], v[204:207]
    s_bitcmp1_b32 s74, 7
    s_cselect_b32 s66, s65, 4096
    buffer_store_dwordx4 v[92:95], v31, s[28:31], s66 offen offset:3072 sc1
    s_waitcnt lgkmcnt(0)
    v_mfma_f32_16x16x32_bf16 v[208:211], a[240:243], a[192:195], v[208:211]
    ds_read_b64_tr_b16 a[224:225], v21 offset:128
    ds_read_b64_tr_b16 a[226:227], v21 offset:14464
    v_mfma_f32_16x16x32_bf16 v[208:211], a[244:247], a[208:211], v[208:211]
    ds_read_b64_tr_b16 a[228:229], v21 offset:32896
    ds_read_b64_tr_b16 a[230:231], v21 offset:47232
    v_mfma_f32_16x16x32_bf16 v[212:215], a[244:247], a[212:215], v[212:215]
    v_cvt_pk_bf16_f32 v96, v192, v193
    v_cvt_pk_bf16_f32 v97, v194, v195
    v_mfma_f32_16x16x32_bf16 v[212:215], a[240:243], a[196:199], v[212:215]
    v_cvt_pk_bf16_f32 v98, v196, v197
    v_cvt_pk_bf16_f32 v99, v198, v199
    v_mfma_f32_16x16x32_bf16 v[216:219], a[240:243], a[200:203], v[216:219]
    s_bitcmp1_b32 s74, 8
    s_cselect_b32 s66, s65, 8192
    buffer_store_dwordx4 v[96:99], v31, s[28:31], s66 offen offset:0 sc1
    v_mfma_f32_16x16x32_bf16 v[216:219], a[244:247], a[216:219], v[216:219]
    v_cvt_pk_bf16_f32 v100, v200, v201
    v_cvt_pk_bf16_f32 v101, v202, v203
    v_mfma_f32_16x16x32_bf16 v[220:223], a[244:247], a[220:223], v[220:223]
    v_cvt_pk_bf16_f32 v102, v204, v205
    v_cvt_pk_bf16_f32 v103, v206, v207
    v_mfma_f32_16x16x32_bf16 v[220:223], a[240:243], a[204:207], v[220:223]
    s_bitcmp1_b32 s74, 9
    s_cselect_b32 s66, s65, 8192
    buffer_store_dwordx4 v[100:103], v31, s[28:31], s66 offen offset:1024 sc1
    s_waitcnt lgkmcnt(0)
    v_mfma_f32_16x16x32_bf16 v[224:227], a[224:227], a[192:195], v[224:227]
    v_mfma_f32_16x16x32_bf16 v[224:227], a[228:231], a[208:211], v[224:227]
    v_mfma_f32_16x16x32_bf16 v[228:231], a[228:231], a[212:215], v[228:231]
    v_cvt_pk_bf16_f32 v104, v208, v209
    v_cvt_pk_bf16_f32 v105, v210, v211
    v_mfma_f32_16x16x32_bf16 v[228:231], a[224:227], a[196:199], v[228:231]
    v_cvt_pk_bf16_f32 v106, v212, v213
    v_cvt_pk_bf16_f32 v107, v214, v215
    v_mfma_f32_16x16x32_bf16 v[232:235], a[224:227], a[200:203], v[232:235]
    s_bitcmp1_b32 s74, 10
    s_cselect_b32 s66, s65, 8192
    buffer_store_dwordx4 v[104:107], v31, s[28:31], s66 offen offset:2048 sc1
    v_mfma_f32_16x16x32_bf16 v[232:235], a[228:231], a[216:219], v[232:235]
    v_cvt_pk_bf16_f32 v108, v216, v217
    v_cvt_pk_bf16_f32 v109, v218, v219
    v_mfma_f32_16x16x32_bf16 v[236:239], a[228:231], a[220:223], v[236:239]
    v_cvt_pk_bf16_f32 v110, v220, v221
    v_cvt_pk_bf16_f32 v111, v222, v223
    v_mfma_f32_16x16x32_bf16 v[236:239], a[224:227], a[204:207], v[236:239]
    s_bitcmp1_b32 s74, 11
    s_cselect_b32 s66, s65, 8192
    buffer_store_dwordx4 v[108:111], v31, s[28:31], s66 offen offset:3072 sc1
    v_cvt_pk_bf16_f32 v112, v224, v225
    v_cvt_pk_bf16_f32 v113, v226, v227
    v_cvt_pk_bf16_f32 v114, v228, v229
    v_cvt_pk_bf16_f32 v115, v230, v231
    s_bitcmp1_b32 s74, 12
    s_cselect_b32 s66, s65, 12288
    buffer_store_dwordx4 v[112:115], v31, s[28:31], s66 offen offset:0 sc1
    v_cvt_pk_bf16_f32 v116, v232, v233
    v_cvt_pk_bf16_f32 v117, v234, v235
    v_cvt_pk_bf16_f32 v118, v236, v237
    v_cvt_pk_bf16_f32 v119, v238, v239
    s_bitcmp1_b32 s74, 13
    s_cselect_b32 s66, s65, 12288
    buffer_store_dwordx4 v[116:119], v31, s[28:31], s66 offen offset:1024 sc1
    s_lshl3_add_u32 s3, s59, s60
    s_lshl_b32 s4, s61, 2
    s_add_u32 s4, s4, s58
    s_lshr_b32 s4, s61, 1
    s_lshl2_add_u32 s4, s4, s58
    s_lshl1_add_u32 s4, s4, s69
    s_mul_i32 s5, s3, 917504
    s_add_u32 s12, s56, s5
    s_addc_u32 s13, s57, 0
    s_mov_b32 s14, 917504
    s_mov_b32 s16, s92
    s_mov_b32 s17, s93
    s_mov_b32 s18, 917504
    s_lshl_b32 s5, s4, 10
    v_lshl_add_u32 v1, v0, 4, s5
    s_and_b32 s5, s4, 1
    s_lshr_b32 s6, s4, 1
    s_lshl1_add_u32 s5, s60, s5
    s_mul_i32 s63, s5, 57344
    s_mul_i32 s7, s59, 896
    s_add_u32 s63, s63, s7
    s_lshl_b32 s6, s6, 5
    s_add_u32 s63, s63, s6
    v_and_b32 v3, 15, v0
    v_mul_u32_u24 v2, 1792, v3
    v_lshrrev_b32 v4, 4, v0
    v_lshl_add_u32 v2, v4, 3, v2
    v_add_u32 v2, s63, v2
    s_and_b32 s5, s61, 0
    s_lshl_b32 s5, s5, 8
    v_lshl_add_u32 v3, v3, 2, s5
    s_lshl_b32 s5, s61, 2
    s_cmp_eq_u32 s58, 0
    s_cselect_b32 s5, s5, 0x80000000
    v_lshl_add_u32 v4, v0, 8, s5
    v_mov_b32 v5, 1
    v_readfirstlane_b32 s6, v36
    s_mov_b32 s7, 1048576
    s_cmp_eq_u32 s6, 1
    s_cbranch_scc1 L_ready
L_rdy_spin:
    buffer_load_dword v36, off, s[8:11], 0 sc1
    s_waitcnt vmcnt(0)
    v_readfirstlane_b32 s6, v36
    s_sub_u32 s7, s7, 1
    s_cmp_eq_u32 s7, 0
    s_cbranch_scc1 L_ready
    s_cmp_eq_u32 s6, 1
    s_cbranch_scc0 L_rdy_spin
L_ready:
    s_mov_b32 s5, 147456
    v_lshl_add_u32 v7, v0, 4, s5
    s_add_u32 s6, s75, 0
    s_cmp_lt_u32 s6, 7
    s_cbranch_scc0 L_own0
    s_lshl1_add_u32 s6, s6, s69
    s_lshl_b32 s6, s6, 2
    s_set_gpr_idx_on s6, gpr_idx(SRC0)
    s_nop 1
    v_mov_b32 v8, v64
    v_mov_b32 v9, v65
    v_mov_b32 v10, v66
    v_mov_b32 v11, v67
    s_set_gpr_idx_off
    s_nop 1
    ds_write_b128 v7, v[8:11] offset:0
L_own0:
    s_add_u32 s6, s75, 1
    s_cmp_lt_u32 s6, 7
    s_cbranch_scc0 L_own1
    s_lshl1_add_u32 s6, s6, s69
    s_lshl_b32 s6, s6, 2
    s_set_gpr_idx_on s6, gpr_idx(SRC0)
    s_nop 1
    v_mov_b32 v12, v64
    v_mov_b32 v13, v65
    v_mov_b32 v14, v66
    v_mov_b32 v15, v67
    s_set_gpr_idx_off
    s_nop 1
    ds_write_b128 v7, v[12:15] offset:1024
L_own1:
    s_add_u32 s6, s75, 2
    s_cmp_lt_u32 s6, 7
    s_cbranch_scc0 L_own2
    s_lshl1_add_u32 s6, s6, s69
    s_lshl_b32 s6, s6, 2
    s_set_gpr_idx_on s6, gpr_idx(SRC0)
    s_nop 1
    v_mov_b32 v16, v64
    v_mov_b32 v17, v65
    v_mov_b32 v18, v66
    v_mov_b32 v19, v67
    s_set_gpr_idx_off
    s_nop 1
    ds_write_b128 v7, v[16:19] offset:2048
L_own2:
    s_add_u32 s6, s75, 3
    s_cmp_lt_u32 s6, 7
    s_cbranch_scc0 L_own3
    s_lshl1_add_u32 s6, s6, s69
    s_lshl_b32 s6, s6, 2
    s_set_gpr_idx_on s6, gpr_idx(SRC0)
    s_nop 1
    v_mov_b32 v20, v64
    v_mov_b32 v21, v65
    v_mov_b32 v22, v66
    v_mov_b32 v23, v67
    s_set_gpr_idx_off
    s_nop 1
    ds_write_b128 v7, v[20:23] offset:3072
L_own3:
    v_add_u32 v7, s68, v7
    s_waitcnt lgkmcnt(0)
    s_waitcnt vmcnt(0)
    s_barrier
    buffer_store_dword v5, v4, s[32:35], 0 offen sc1
    s_cmp_ge_u32 s61, 14
    s_cbranch_scc1 L_fin
    s_mov_b32 s7, 1048576
    s_mov_b32 s4, 0x00003f80
    s_mov_b32 s5, 0x3f800000
    s_mov_b32 s6, 28672
    ds_read_b128 v[8:11], v7
    s_cmp_lg_u32 s58, 0
    s_cbranch_scc1 L_go
L_poll:
    buffer_load_dword v24, v3, s[32:35], 0 offen sc1
    s_waitcnt vmcnt(0)
    v_cmp_ne_u32 vcc, 1, v24
    s_nop 1
    s_cbranch_vccz L_go
    s_sub_u32 s7, s7, 1
    s_cmp_eq_u32 s7, 0
    s_cbranch_scc0 L_poll
L_go:
    s_barrier
    s_cmp_le_u32 s61, 0
    s_cselect_b32 s66, 1, 0
    s_mul_i32 s66, s66, 57344
    buffer_load_dwordx4 v[64:67], v1, s[12:15], s66 offen sc1
    s_cmp_le_u32 s61, 1
    s_cselect_b32 s66, 2, 1
    s_mul_i32 s66, s66, 57344
    buffer_load_dwordx4 v[68:71], v1, s[12:15], s66 offen sc1
    s_cmp_le_u32 s61, 2
    s_cselect_b32 s66, 3, 2
    s_mul_i32 s66, s66, 57344
    buffer_load_dwordx4 v[72:75], v1, s[12:15], s66 offen sc1
    s_cmp_le_u32 s61, 3
    s_cselect_b32 s66, 4, 3
    s_mul_i32 s66, s66, 57344
    buffer_load_dwordx4 v[76:79], v1, s[12:15], s66 offen sc1
    s_cmp_le_u32 s61, 4
    s_cselect_b32 s66, 5, 4
    s_mul_i32 s66, s66, 57344
    buffer_load_dwordx4 v[80:83], v1, s[12:15], s66 offen sc1
    s_cmp_le_u32 s61, 5
    s_cselect_b32 s66, 6, 5
    s_mul_i32 s66, s66, 57344
    buffer_load_dwordx4 v[84:87], v1, s[12:15], s66 offen sc1
    s_cmp_le_u32 s61, 6
    s_cselect_b32 s66, 7, 6
    s_mul_i32 s66, s66, 57344
    buffer_load_dwordx4 v[88:91], v1, s[12:15], s66 offen sc1
    s_cmp_le_u32 s61, 7
    s_cselect_b32 s66, 8, 7
    s_mul_i32 s66, s66, 57344
    buffer_load_dwordx4 v[92:95], v1, s[12:15], s66 offen sc1
    s_cmp_le_u32 s61, 8
    s_cselect_b32 s66, 9, 8
    s_mul_i32 s66, s66, 57344
    buffer_load_dwordx4 v[96:99], v1, s[12:15], s66 offen sc1
    s_cmp_le_u32 s61, 9
    s_cselect_b32 s66, 10, 9
    s_mul_i32 s66, s66, 57344
    buffer_load_dwordx4 v[100:103], v1, s[12:15], s66 offen sc1
    s_cmp_le_u32 s61, 10
    s_cselect_b32 s66, 11, 10
    s_mul_i32 s66, s66, 57344
    buffer_load_dwordx4 v[104:107], v1, s[12:15], s66 offen sc1
    s_cmp_le_u32 s61, 11
    s_cselect_b32 s66, 12, 11
    s_mul_i32 s66, s66, 57344
    buffer_load_dwordx4 v[108:111], v1, s[12:15], s66 offen sc1
    s_cmp_le_u32 s61, 12
    s_cselect_b32 s66, 13, 12
    s_mul_i32 s66, s66, 57344
    buffer_load_dwordx4 v[112:115], v1, s[12:15], s66 offen sc1
    s_cmp_le_u32 s61, 13
    s_cselect_b32 s66, 14, 13
    s_mul_i32 s66, s66, 57344
    buffer_load_dwordx4 v[116:119], v1, s[12:15], s66 offen sc1
    s_cmp_le_u32 s61, 14
    s_cselect_b32 s66, 15, 14
    s_mul_i32 s66, s66, 57344
    buffer_load_dwordx4 v[120:123], v1, s[12:15], s66 offen sc1
    s_waitcnt lgkmcnt(0)
    v_dot2_f32_bf16 v128, v8, s4, 0
    v_dot2_f32_bf16 v129, v8, s5, 0
    v_dot2_f32_bf16 v130, v9, s4, 0
    v_dot2_f32_bf16 v131, v9, s5, 0
    v_dot2_f32_bf16 v132, v10, s4, 0
    v_dot2_f32_bf16 v133, v10, s5, 0
    v_dot2_f32_bf16 v134, v11, s4, 0
    v_dot2_f32_bf16 v135, v11, s5, 0
    s_waitcnt vmcnt(14)
    v_dot2_f32_bf16 v128, v64, s4, v128
    v_dot2_f32_bf16 v129, v64, s5, v129
    v_dot2_f32_bf16 v130, v65, s4, v130
    v_dot2_f32_bf16 v131, v65, s5, v131
    v_dot2_f32_bf16 v132, v66, s4, v132
    v_dot2_f32_bf16 v133, v66, s5, v133
    v_dot2_f32_bf16 v134, v67, s4, v134
    v_dot2_f32_bf16 v135, v67, s5, v135
    s_waitcnt vmcnt(13)
    v_dot2_f32_bf16 v128, v68, s4, v128
    v_dot2_f32_bf16 v129, v68, s5, v129
    v_dot2_f32_bf16 v130, v69, s4, v130
    v_dot2_f32_bf16 v131, v69, s5, v131
    v_dot2_f32_bf16 v132, v70, s4, v132
    v_dot2_f32_bf16 v133, v70, s5, v133
    v_dot2_f32_bf16 v134, v71, s4, v134
    v_dot2_f32_bf16 v135, v71, s5, v135
    s_waitcnt vmcnt(12)
    v_dot2_f32_bf16 v128, v72, s4, v128
    v_dot2_f32_bf16 v129, v72, s5, v129
    v_dot2_f32_bf16 v130, v73, s4, v130
    v_dot2_f32_bf16 v131, v73, s5, v131
    v_dot2_f32_bf16 v132, v74, s4, v132
    v_dot2_f32_bf16 v133, v74, s5, v133
    v_dot2_f32_bf16 v134, v75, s4, v134
    v_dot2_f32_bf16 v135, v75, s5, v135
    s_waitcnt vmcnt(11)
    v_dot2_f32_bf16 v128, v76, s4, v128
    v_dot2_f32_bf16 v129, v76, s5, v129
    v_dot2_f32_bf16 v130, v77, s4, v130
    v_dot2_f32_bf16 v131, v77, s5, v131
    v_dot2_f32_bf16 v132, v78, s4, v132
    v_dot2_f32_bf16 v133, v78, s5, v133
    v_dot2_f32_bf16 v134, v79, s4, v134
    v_dot2_f32_bf16 v135, v79, s5, v135
    s_waitcnt vmcnt(10)
    v_dot2_f32_bf16 v128, v80, s4, v128
    v_dot2_f32_bf16 v129, v80, s5, v129
    v_dot2_f32_bf16 v130, v81, s4, v130
    v_dot2_f32_bf16 v131, v81, s5, v131
    v_dot2_f32_bf16 v132, v82, s4, v132
    v_dot2_f32_bf16 v133, v82, s5, v133
    v_dot2_f32_bf16 v134, v83, s4, v134
    v_dot2_f32_bf16 v135, v83, s5, v135
    s_waitcnt vmcnt(9)
    v_dot2_f32_bf16 v128, v84, s4, v128
    v_dot2_f32_bf16 v129, v84, s5, v129
    v_dot2_f32_bf16 v130, v85, s4, v130
    v_dot2_f32_bf16 v131, v85, s5, v131
    v_dot2_f32_bf16 v132, v86, s4, v132
    v_dot2_f32_bf16 v133, v86, s5, v133
    v_dot2_f32_bf16 v134, v87, s4, v134
    v_dot2_f32_bf16 v135, v87, s5, v135
    s_waitcnt vmcnt(8)
    v_dot2_f32_bf16 v128, v88, s4, v128
    v_dot2_f32_bf16 v129, v88, s5, v129
    v_dot2_f32_bf16 v130, v89, s4, v130
    v_dot2_f32_bf16 v131, v89, s5, v131
    v_dot2_f32_bf16 v132, v90, s4, v132
    v_dot2_f32_bf16 v133, v90, s5, v133
    v_dot2_f32_bf16 v134, v91, s4, v134
    v_dot2_f32_bf16 v135, v91, s5, v135
    s_waitcnt vmcnt(7)
    v_dot2_f32_bf16 v128, v92, s4, v128
    v_dot2_f32_bf16 v129, v92, s5, v129
    v_dot2_f32_bf16 v130, v93, s4, v130
    v_dot2_f32_bf16 v131, v93, s5, v131
    v_dot2_f32_bf16 v132, v94, s4, v132
    v_dot2_f32_bf16 v133, v94, s5, v133
    v_dot2_f32_bf16 v134, v95, s4, v134
    v_dot2_f32_bf16 v135, v95, s5, v135
    s_waitcnt vmcnt(6)
    v_dot2_f32_bf16 v128, v96, s4, v128
    v_dot2_f32_bf16 v129, v96, s5, v129
    v_dot2_f32_bf16 v130, v97, s4, v130
    v_dot2_f32_bf16 v131, v97, s5, v131
    v_dot2_f32_bf16 v132, v98, s4, v132
    v_dot2_f32_bf16 v133, v98, s5, v133
    v_dot2_f32_bf16 v134, v99, s4, v134
    v_dot2_f32_bf16 v135, v99, s5, v135
    s_waitcnt vmcnt(5)
    v_dot2_f32_bf16 v128, v100, s4, v128
    v_dot2_f32_bf16 v129, v100, s5, v129
    v_dot2_f32_bf16 v130, v101, s4, v130
    v_dot2_f32_bf16 v131, v101, s5, v131
    v_dot2_f32_bf16 v132, v102, s4, v132
    v_dot2_f32_bf16 v133, v102, s5, v133
    v_dot2_f32_bf16 v134, v103, s4, v134
    v_dot2_f32_bf16 v135, v103, s5, v135
    s_waitcnt vmcnt(4)
    v_dot2_f32_bf16 v128, v104, s4, v128
    v_dot2_f32_bf16 v129, v104, s5, v129
    v_dot2_f32_bf16 v130, v105, s4, v130
    v_dot2_f32_bf16 v131, v105, s5, v131
    v_dot2_f32_bf16 v132, v106, s4, v132
    v_dot2_f32_bf16 v133, v106, s5, v133
    v_dot2_f32_bf16 v134, v107, s4, v134
    v_dot2_f32_bf16 v135, v107, s5, v135
    s_waitcnt vmcnt(3)
    v_dot2_f32_bf16 v128, v108, s4, v128
    v_dot2_f32_bf16 v129, v108, s5, v129
    v_dot2_f32_bf16 v130, v109, s4, v130
    v_dot2_f32_bf16 v131, v109, s5, v131
    v_dot2_f32_bf16 v132, v110, s4, v132
    v_dot2_f32_bf16 v133, v110, s5, v133
    v_dot2_f32_bf16 v134, v111, s4, v134
    v_dot2_f32_bf16 v135, v111, s5, v135
    s_waitcnt vmcnt(2)
    v_dot2_f32_bf16 v128, v112, s4, v128
    v_dot2_f32_bf16 v129, v112, s5, v129
    v_dot2_f32_bf16 v130, v113, s4, v130
    v_dot2_f32_bf16 v131, v113, s5, v131
    v_dot2_f32_bf16 v132, v114, s4, v132
    v_dot2_f32_bf16 v133, v114, s5, v133
    v_dot2_f32_bf16 v134, v115, s4, v134
    v_dot2_f32_bf16 v135, v115, s5, v135
    s_waitcnt vmcnt(1)
    v_dot2_f32_bf16 v128, v116, s4, v128
    v_dot2_f32_bf16 v129, v116, s5, v129
    v_dot2_f32_bf16 v130, v117, s4, v130
    v_dot2_f32_bf16 v131, v117, s5, v131
    v_dot2_f32_bf16 v132, v118, s4, v132
    v_dot2_f32_bf16 v133, v118, s5, v133
    v_dot2_f32_bf16 v134, v119, s4, v134
    v_dot2_f32_bf16 v135, v119, s5, v135
    s_waitcnt vmcnt(0)
    v_dot2_f32_bf16 v128, v120, s4, v128
    v_dot2_f32_bf16 v129, v120, s5, v129
    v_dot2_f32_bf16 v130, v121, s4, v130
    v_dot2_f32_bf16 v131, v121, s5, v131
    v_dot2_f32_bf16 v132, v122, s4, v132
    v_dot2_f32_bf16 v133, v122, s5, v133
    v_dot2_f32_bf16 v134, v123, s4, v134
    v_dot2_f32_bf16 v135, v123, s5, v135
    v_cvt_pk_bf16_f32 v44, v128, v129
    v_cvt_pk_bf16_f32 v45, v130, v131
    v_cvt_pk_bf16_f32 v46, v132, v133
    v_cvt_pk_bf16_f32 v47, v134, v135
    buffer_store_dwordx2 v[44:45], v2, s[16:19], 0 offen
    buffer_store_dwordx2 v[46:47], v2, s[16:19], s6 offen
L_fin:
L_main_end:
    s_endpgm
.section .rodata,"a"
.p2align 6
.amdhsa_kernel concat_heads__gqa_block_cached__mha_block_cached__near_ridge_kernel
  .amdhsa_next_free_vgpr 512
  .amdhsa_next_free_sgpr 102
  .amdhsa_accum_offset 256
  .amdhsa_group_segment_fixed_size 0
  .amdhsa_kernarg_size 104
  .amdhsa_user_sgpr_count 2
  .amdhsa_user_sgpr_kernarg_segment_ptr 1
  .amdhsa_system_sgpr_workgroup_id_x 1
  .amdhsa_float_denorm_mode_32 3
.end_amdhsa_kernel
```
